```python
import torch

def _softmax(x, axis=-1):
    return torch.softmax(x, dim=axis)
def _gelu(x):
    return torch.nn.functional.gelu(x, approximate="tanh")
def _silu(x):
    return torch.nn.functional.silu(x)
def _sigmoid(x):
    return torch.sigmoid(x)
def _layernorm(x, axis=-1, eps=1e-5):
    m = x.mean(dim=axis, keepdim=True)
    v = x.var(dim=axis, keepdim=True, unbiased=False)
    return (x - m) / torch.sqrt(v + eps)
def _scatter_add(tgt, idx, src, axis=0):
    return tgt.clone().index_add_(axis, idx, src)
def _segment_sum(src, seg, n):
    out = torch.zeros((n,) + src.shape[1:], dtype=src.dtype)
    return out.index_add_(0, seg, src)
def _pad(x, pw):
    flat = tuple(v for pair in reversed(pw) for v in pair)
    return torch.nn.functional.pad(x, flat)

kernel_name = 'standalone__mha_block_cached__near_ridge'

def setup_inputs():

    _w = (lambda a: (lambda t: t.to(torch.bfloat16) if t.is_floating_point() else t)(torch.as_tensor(a)))
    B, Sq, D = 16, 144, 576
    H, Sk, Dh = 32, 1024, 128
    return {
        "x": _w((lambda *s: torch.randn(*s, dtype=torch.bfloat16) * 0.8)(B, Sq, D)),
        "k_cache": _w((lambda *s: torch.randn(*s, dtype=torch.bfloat16) * 0.8)(B, H, Sk, Dh)),
        "v_cache": _w((lambda *s: torch.randn(*s, dtype=torch.bfloat16) * 0.05)(B, H, Sk, Dh)),
        "wq": _w((lambda *s: torch.randn(*s, dtype=torch.bfloat16) * 0.8)(D, H * Dh) * (D ** -0.5)),
        "wo": _w((lambda *s: torch.randn(*s, dtype=torch.bfloat16) * 0.05)(H * Dh, D) * ((H * Dh) ** -0.5)),
    }

def reference(x, k_cache, v_cache, wq, wo):
    B, Sq, D = x.shape
    H, Dh = 32, 128
    q = (lambda x, *d: x.permute(*d))((x @ wq).reshape(B, Sq, H, Dh), 0, 2, 1, 3)
    scores = torch.einsum("bhqd,bhkd->bhqk", q, k_cache) * (Dh ** -0.5)
    p = _softmax(scores, axis=-1)
    o = torch.einsum("bhqk,bhkd->bhqd", p, v_cache)
    return (lambda x, *d: x.permute(*d))(o, 0, 2, 1, 3).reshape(B, Sq, H * Dh) @ wo
```

```asm
; @launch grid=(256,1,1) block=(512,1,1) lds=163840
  .amdgcn_target "amdgcn-amd-amdhsa--gfx950"
.text
  .globl standalone__mha_block_cached__near_ridge_kernel
.p2align 8
.type standalone__mha_block_cached__near_ridge_kernel,@function
standalone__mha_block_cached__near_ridge_kernel:
  s_cmp_ge_u32 s2, 256
  s_cbranch_scc1 L_end
    s_load_dwordx16 s[4:19], s[0:1], 0
    s_memrealtime s[74:75]
  v_lshrrev_b32 v1, 6, v0
  v_and_b32 v0, 63, v0
  v_readfirstlane_b32 s42, v1
  v_and_b32 v2, 15, v0
  v_lshrrev_b32 v3, 4, v0
  s_mov_b32 s99, 0
  s_lshr_b32 s47, s2, 6
  s_bfe_u32 s3, s2, 0x20001
  s_and_b32 s43, s42, 3
  s_lshr_b32 s44, s42, 2
  s_and_b32 s52, s2, 1
  s_lshl_b32 s52, s52, 3
  s_bfe_u32 s53, s2, 0x30003
  s_add_u32 s55, s52, s53
  s_lshl_b32 s52, s3, 2
  s_add_u32 s52, s52, s47
  s_lshl_b32 s56, s52, 1
  s_lshl_b32 s52, s47, 1
  s_add_u32 s98, s52, s53
  s_cmp_ge_u32 s98, 9
  s_cselect_b32 s52, 9, 0
  s_sub_u32 s98, s98, s52
  s_cmp_eq_u32 s44, 0
  s_cbranch_scc1 L_x_pro
  v_lshlrev_b32 v212, 1, v3
  v_xor_b32 v212, v212, v2
  v_lshlrev_b32 v212, 4, v212
  v_lshl_add_u32 v232, v3, 13, v212
  v_xor_b32 v233, 128, v232
  v_lshrrev_b32 v212, 3, v0
  v_mul_u32_u24 v212, 1152, v212
  v_and_b32 v213, 7, v0
  v_xor_b32 v213, v213, v3
  v_lshl_add_u32 v234, v213, 4, v212
  v_xor_b32 v235, 64, v234
  s_and_b32 s52, s43, 1
  s_lshl_b32 s53, s52, 6
  v_xor_b32 v231, s53, v234
  s_lshl_b32 s57, s43, 12
  s_lshl_b32 s58, s43, 17
  s_mul_i32 s59, s43, 36864
  s_add_u32 s52, s52, 16
  s_mul_i32 s60, s52, 9216
  s_lshl_b32 s61, s52, 10
  s_lshl_b32 s52, s98, 19
  s_add_u32 s58, s58, s52
  s_lshl_b32 s52, s98, 7
  s_add_u32 s59, s59, s52
  s_add_u32 s60, s60, s52
  s_mov_b32 s62, s98
  s_mul_i32 s52, s55, 165888
  s_lshl_b32 s53, s56, 8
  s_sub_u32 s54, 4718592, s53
    s_waitcnt lgkmcnt(0)
  s_add_u32 s20, s4, s52
  s_addc_u32 s21, s5, 0
  s_mov_b32 s22, 165888
  s_mov_b32 s23, 0x20000
  s_add_u32 s24, s10, s53
  s_addc_u32 s25, s11, 0
  s_mov_b32 s26, s54
  s_mov_b32 s27, 0x20000
  s_add_u32 m0, s57, 83968
  s_add_u32 s52, s58, 0
  buffer_load_dwordx4 v232, s[24:27], s52 offen lds
  s_add_u32 m0, s57, 84992
  s_add_u32 s52, s58, 32768
  buffer_load_dwordx4 v232, s[24:27], s52 offen lds
  s_add_u32 m0, s57, 86016
  s_add_u32 s52, s58, 65536
  buffer_load_dwordx4 v233, s[24:27], s52 offen lds
  s_add_u32 m0, s57, 87040
  s_add_u32 s52, s58, 98304
  buffer_load_dwordx4 v233, s[24:27], s52 offen lds
  s_add_u32 m0, s57, 65536
  s_add_u32 s52, s59, 0
  buffer_load_dwordx4 v234, s[20:23], s52 offen lds
  s_add_u32 m0, s57, 66560
  s_add_u32 s52, s59, 9216
  buffer_load_dwordx4 v235, s[20:23], s52 offen lds
  s_add_u32 m0, s57, 67584
  s_add_u32 s52, s59, 18432
  buffer_load_dwordx4 v234, s[20:23], s52 offen lds
  s_add_u32 m0, s57, 68608
  s_add_u32 s52, s59, 27648
  buffer_load_dwordx4 v235, s[20:23], s52 offen lds
  s_add_u32 m0, s61, 65536
  s_add_u32 s62, s62, 1
  buffer_load_dwordx4 v231, s[20:23], s60 offen lds
  s_cmp_eq_u32 s62, 9
  s_cselect_b32 s62, 0, s62
  s_cselect_b32 s52, -16, 2
  s_lshl_b32 s52, s52, 6
  s_add_u32 s59, s59, s52
  s_add_u32 s60, s60, s52
  s_lshl_b32 s52, s52, 12
  s_add_u32 s58, s58, s52
  s_branch L_common
L_x_pro:
  s_bfe_u32 s52, s2, 0x20003
  s_cmp_lg_u32 s52, s43
  s_cbranch_scc1 L_code1
    s_getpc_b64 s[100:101]
L_code0:
    s_sub_u32 s100, s100, L_code0-standalone__mha_block_cached__near_ridge_kernel
    s_subb_u32 s101, s101, 0
  s_lshl_b32 s52, s43, 13
  v_lshl_add_u32 v212, v0, 7, s52
  v_min_u32 v212, L_end-standalone__mha_block_cached__near_ridge_kernel, v212
  global_load_dword v252, v212, s[100:101]
L_code1:
  v_lshlrev_b32 v212, 2, v0
  v_add_u32 v212, 163584, v212
  v_mov_b32 v213, 0
  v_subrev_u32 v214, 7, v0
  v_cmp_gt_u32 vcc, 3, v214
  s_nop 1
  v_cndmask_b32 v213, v213, 32, vcc
  s_cmp_lg_u32 s42, 0
  s_cbranch_scc1 L_noinit
  ds_write_b32 v212, v213 offset:0
L_noinit:
    s_waitcnt lgkmcnt(0)
L_common:
  s_lshl_b32 s52, s55, 5
  s_add_u32 s52, s52, s56
  s_lshr_b32 s53, s52, 14
  s_lshl_b32 s52, s52, 18
  s_add_u32 s28, s6, s52
  s_addc_u32 s29, s7, s53
  s_mov_b32 s30, 524288
  s_mov_b32 s31, 0x20000
  s_add_u32 s32, s8, s52
  s_addc_u32 s33, s9, s53
  s_mov_b32 s34, 524288
  s_mov_b32 s35, 0x20000
  s_mov_b32 s88, s16
  s_mov_b32 s89, s17
  s_mov_b32 s90, 256
  s_mov_b32 s91, 0x20000
  s_or_b32 s52, s2, s42
  s_cmp_lg_u32 s52, 0
  s_cbranch_scc1 L_ntag
  s_or_b32 s74, s74, 1
  v_mov_b32 v212, s74
  v_mov_b32 v213, 0
  s_mov_b64 exec, 1
  buffer_store_dword v212, v213, s[88:91], 0 offen sc1
  s_mov_b64 exec, -1
L_ntag:
  s_mul_i32 s52, s55, 1179648
  s_lshl_b32 s53, s56, 12
  s_add_u32 s52, s52, s53
  s_sub_u32 s54, 1179648, s53
  s_add_u32 s36, s18, s52
  s_addc_u32 s37, s19, 0
  s_mov_b32 s38, s54
  s_mov_b32 s39, 0x20000
  s_add_u32 s68, s18, 33554432
  s_addc_u32 s69, s19, 0
  s_mov_b32 s70, 2048
  s_mov_b32 s71, 0x20000
  s_mov_b32 s64, 1040356334
  s_mov_b32 s65, 1040356334
  s_cmp_eq_u32 s44, 0
  s_cbranch_scc1 L_x_p0
  v_add_u32 v212, 0, v3
  v_xor_b32 v212, v212, v2
  v_lshlrev_b32 v212, 4, v212
  v_lshl_add_u32 v132, v3, 8, v212
  v_add_u32 v212, 4, v3
  v_xor_b32 v212, v212, v2
  v_lshlrev_b32 v212, 4, v212
  v_lshl_add_u32 v133, v3, 8, v212
  v_add_u32 v212, 8, v3
  v_xor_b32 v212, v212, v2
  v_lshlrev_b32 v212, 4, v212
  v_lshl_add_u32 v134, v3, 8, v212
  v_add_u32 v212, 12, v3
  v_xor_b32 v212, v212, v2
  v_lshlrev_b32 v212, 4, v212
  v_lshl_add_u32 v135, v3, 8, v212
  v_add_u32 v212, 0, v3
  v_lshlrev_b32 v212, 1, v212
  v_xor_b32 v212, v212, v2
  v_lshlrev_b32 v212, 4, v212
  v_lshl_add_u32 v136, v3, 8, v212
  v_add_u32 v212, 4, v3
  v_lshlrev_b32 v212, 1, v212
  v_xor_b32 v212, v212, v2
  v_lshlrev_b32 v212, 4, v212
  v_lshl_add_u32 v137, v3, 8, v212
  v_lshlrev_b32 v145, 2, v0
  v_add_u32 v145, 163328, v145
  s_mov_b32 s53, 163584
    v_writelane_b32 v145, s53, 0
  s_nop 0
  v_lshlrev_b32 v146, 2, v0
  v_add_u32 v146, 163328, v146
  s_mov_b32 s53, 163728
    v_writelane_b32 v146, s53, 0
  s_nop 0
  v_min_u32 v212, 7, v0
  v_lshlrev_b32 v138, 2, v212
  v_add_u32 v138, 163600, v138
  v_cmp_lt_u32 vcc, 2, v212
  v_mov_b32 v139, 0
  v_mov_b32 v140, 32
  v_cndmask_b32 v139, v139, 32, vcc
  v_cndmask_b32 v140, v140, 64, vcc
  v_cmp_lt_u32 vcc, 5, v212
  s_nop 1
  v_cndmask_b32 v139, v139, 0, vcc
  v_cndmask_b32 v140, v140, 0, vcc
  v_lshrrev_b32 v212, 2, v0
  v_mul_u32_u24 v212, 1152, v212
  v_lshrrev_b32 v213, 5, v0
  v_lshlrev_b32 v213, 1, v213
  v_and_b32 v214, 3, v0
  v_xor_b32 v213, v213, v214
  v_lshl_add_u32 v156, v213, 4, v212
  v_add_u32 v157, 17408, v156
  v_add_u32 v158, 34816, v156
  v_add_u32 v159, 52224, v156
  v_add_u32 v160, 73728, v156
  v_add_u32 v161, 91136, v156
  v_add_u32 v162, 108544, v156
  v_add_u32 v163, 125952, v156
  v_add_u32 v164, 147456, v156
  v_add_u32 v148, 256, v232
  v_add_u32 v149, 32000, v232
  v_add_u32 v150, 63744, v233
  v_add_u32 v151, 95488, v233
  v_add_u32 v152, 131328, v232
  v_add_u32 v153, 163072, v232
  v_add_u32 v154, 194816, v233
  v_add_u32 v155, 226560, v233
  v_add_u32 v212, 0, v3
  v_xor_b32 v212, v212, v2
  v_lshlrev_b32 v212, 4, v212
  v_lshl_add_u32 v236, v2, 8, v212
  v_add_u32 v212, 4, v3
  v_xor_b32 v212, v212, v2
  v_lshlrev_b32 v212, 4, v212
  v_lshl_add_u32 v237, v2, 8, v212
  v_add_u32 v212, 8, v3
  v_xor_b32 v212, v212, v2
  v_lshlrev_b32 v212, 4, v212
  v_lshl_add_u32 v238, v2, 8, v212
  v_add_u32 v212, 12, v3
  v_xor_b32 v212, v212, v2
  v_lshlrev_b32 v212, 4, v212
  v_lshl_add_u32 v239, v2, 8, v212
  v_lshrrev_b32 v214, 2, v2
  v_lshl_add_u32 v212, v3, 2, v214
  v_and_b32 v215, 3, v0
  v_lshlrev_b32 v215, 3, v215
  v_lshl_add_u32 v213, v212, 8, v215
  v_add_u32 v213, 8192, v213
  v_and_b32 v212, 7, v212
  v_xor_b32 v216, 0, v212
  v_lshl_add_u32 v240, v216, 5, v213
  v_xor_b32 v216, 1, v212
  v_lshl_add_u32 v241, v216, 5, v213
  v_xor_b32 v216, 2, v212
  v_lshl_add_u32 v242, v216, 5, v213
  v_xor_b32 v216, 3, v212
  v_lshl_add_u32 v243, v216, 5, v213
  v_xor_b32 v216, 4, v212
  v_lshl_add_u32 v244, v216, 5, v213
  v_xor_b32 v216, 5, v212
  v_lshl_add_u32 v245, v216, 5, v213
  v_xor_b32 v216, 6, v212
  v_lshl_add_u32 v246, v216, 5, v213
  v_xor_b32 v216, 7, v212
  v_lshl_add_u32 v247, v216, 5, v213
  v_mov_b32 v4, 163584
  v_mov_b32 v128, 0x3f803f80
  v_mov_b32 v129, 0x3f803f80
  v_mov_b32 v130, 0x3f803f80
  v_mov_b32 v131, 0x3f803f80
  s_add_u32 m0, s57, 118784
  s_add_u32 s52, s58, 0
  buffer_load_dwordx4 v232, s[24:27], s52 offen lds
  s_add_u32 m0, s57, 119808
  s_add_u32 s52, s58, 32768
  buffer_load_dwordx4 v232, s[24:27], s52 offen lds
  s_add_u32 m0, s57, 120832
  s_add_u32 s52, s58, 65536
  buffer_load_dwordx4 v233, s[24:27], s52 offen lds
  s_add_u32 m0, s57, 121856
  s_add_u32 s52, s58, 98304
  buffer_load_dwordx4 v233, s[24:27], s52 offen lds
  s_add_u32 m0, s57, 100352
  s_add_u32 s52, s59, 0
  buffer_load_dwordx4 v234, s[20:23], s52 offen lds
  s_add_u32 m0, s57, 101376
  s_add_u32 s52, s59, 9216
  buffer_load_dwordx4 v235, s[20:23], s52 offen lds
  s_add_u32 m0, s57, 102400
  s_add_u32 s52, s59, 18432
  buffer_load_dwordx4 v234, s[20:23], s52 offen lds
  s_add_u32 m0, s57, 103424
  s_add_u32 s52, s59, 27648
  buffer_load_dwordx4 v235, s[20:23], s52 offen lds
  s_add_u32 m0, s61, 100352
  s_add_u32 s62, s62, 1
  buffer_load_dwordx4 v231, s[20:23], s60 offen lds
  s_cmp_eq_u32 s62, 9
  s_cselect_b32 s62, 0, s62
  s_cselect_b32 s52, -16, 2
  s_lshl_b32 s52, s52, 6
  s_add_u32 s59, s59, s52
  s_add_u32 s60, s60, s52
  s_lshl_b32 s52, s52, 12
  s_add_u32 s58, s58, s52
  s_waitcnt vmcnt(9)
  s_barrier
  s_add_u32 m0, s57, 49152
  s_add_u32 s52, s58, 0
  buffer_load_dwordx4 v232, s[24:27], s52 offen lds
  s_add_u32 m0, s57, 50176
  s_add_u32 s52, s58, 32768
  buffer_load_dwordx4 v232, s[24:27], s52 offen lds
  s_add_u32 m0, s57, 51200
  s_add_u32 s52, s58, 65536
  buffer_load_dwordx4 v233, s[24:27], s52 offen lds
  s_add_u32 m0, s57, 52224
  s_add_u32 s52, s58, 98304
  buffer_load_dwordx4 v233, s[24:27], s52 offen lds
  s_add_u32 m0, s57, 135168
  s_add_u32 s52, s59, 0
  buffer_load_dwordx4 v234, s[20:23], s52 offen lds
  s_add_u32 m0, s57, 136192
  s_add_u32 s52, s59, 9216
  buffer_load_dwordx4 v235, s[20:23], s52 offen lds
  s_add_u32 m0, s57, 137216
  s_add_u32 s52, s59, 18432
  buffer_load_dwordx4 v234, s[20:23], s52 offen lds
  s_add_u32 m0, s57, 138240
  s_add_u32 s52, s59, 27648
  buffer_load_dwordx4 v235, s[20:23], s52 offen lds
  s_add_u32 m0, s61, 135168
  s_add_u32 s62, s62, 1
  buffer_load_dwordx4 v231, s[20:23], s60 offen lds
  s_cmp_eq_u32 s62, 9
  s_cselect_b32 s62, 0, s62
  s_cselect_b32 s52, -16, 2
  s_lshl_b32 s52, s52, 6
  s_add_u32 s59, s59, s52
  s_add_u32 s60, s60, s52
  s_lshl_b32 s52, s52, 12
  s_add_u32 s58, s58, s52
  s_waitcnt vmcnt(9)
  s_barrier
  s_add_u32 m0, s57, 83968
  s_add_u32 s52, s58, 0
  buffer_load_dwordx4 v232, s[24:27], s52 offen lds
  s_add_u32 m0, s57, 84992
  s_add_u32 s52, s58, 32768
  buffer_load_dwordx4 v232, s[24:27], s52 offen lds
  s_add_u32 m0, s57, 86016
  s_add_u32 s52, s58, 65536
  buffer_load_dwordx4 v233, s[24:27], s52 offen lds
  s_add_u32 m0, s57, 87040
  s_add_u32 s52, s58, 98304
  buffer_load_dwordx4 v233, s[24:27], s52 offen lds
  s_add_u32 m0, s57, 65536
  s_add_u32 s52, s59, 0
  buffer_load_dwordx4 v234, s[20:23], s52 offen lds
  s_add_u32 m0, s57, 66560
  s_add_u32 s52, s59, 9216
  buffer_load_dwordx4 v235, s[20:23], s52 offen lds
  s_add_u32 m0, s57, 67584
  s_add_u32 s52, s59, 18432
  buffer_load_dwordx4 v234, s[20:23], s52 offen lds
  s_add_u32 m0, s57, 68608
  s_add_u32 s52, s59, 27648
  buffer_load_dwordx4 v235, s[20:23], s52 offen lds
  s_add_u32 m0, s61, 65536
  s_add_u32 s62, s62, 1
  buffer_load_dwordx4 v231, s[20:23], s60 offen lds
  s_cmp_eq_u32 s62, 9
  s_cselect_b32 s62, 0, s62
  s_cselect_b32 s52, -16, 2
  s_lshl_b32 s52, s52, 6
  s_add_u32 s59, s59, s52
  s_add_u32 s60, s60, s52
  s_lshl_b32 s52, s52, 12
  s_add_u32 s58, s58, s52
  s_waitcnt vmcnt(9)
  s_barrier
  s_add_u32 m0, s57, 118784
  s_add_u32 s52, s58, 0
  buffer_load_dwordx4 v232, s[24:27], s52 offen lds
  s_add_u32 m0, s57, 119808
  s_add_u32 s52, s58, 32768
  buffer_load_dwordx4 v232, s[24:27], s52 offen lds
  s_add_u32 m0, s57, 120832
  s_add_u32 s52, s58, 65536
  buffer_load_dwordx4 v233, s[24:27], s52 offen lds
  s_add_u32 m0, s57, 121856
  s_add_u32 s52, s58, 98304
  buffer_load_dwordx4 v233, s[24:27], s52 offen lds
  s_add_u32 m0, s57, 100352
  s_add_u32 s52, s59, 0
  buffer_load_dwordx4 v234, s[20:23], s52 offen lds
  s_add_u32 m0, s57, 101376
  s_add_u32 s52, s59, 9216
  buffer_load_dwordx4 v235, s[20:23], s52 offen lds
  s_add_u32 m0, s57, 102400
  s_add_u32 s52, s59, 18432
  buffer_load_dwordx4 v234, s[20:23], s52 offen lds
  s_add_u32 m0, s57, 103424
  s_add_u32 s52, s59, 27648
  buffer_load_dwordx4 v235, s[20:23], s52 offen lds
  s_add_u32 m0, s61, 100352
  s_add_u32 s62, s62, 1
  buffer_load_dwordx4 v231, s[20:23], s60 offen lds
  s_cmp_eq_u32 s62, 9
  s_cselect_b32 s62, 0, s62
  s_cselect_b32 s52, -16, 2
  s_lshl_b32 s52, s52, 6
  s_add_u32 s59, s59, s52
  s_add_u32 s60, s60, s52
  s_lshl_b32 s52, s52, 12
  s_add_u32 s58, s58, s52
  s_waitcnt vmcnt(9)
  s_barrier
  s_add_u32 m0, s57, 49152
  s_add_u32 s52, s58, 0
  buffer_load_dwordx4 v232, s[24:27], s52 offen lds
  s_add_u32 m0, s57, 50176
  s_add_u32 s52, s58, 32768
  buffer_load_dwordx4 v232, s[24:27], s52 offen lds
  s_add_u32 m0, s57, 51200
  s_add_u32 s52, s58, 65536
  buffer_load_dwordx4 v233, s[24:27], s52 offen lds
  s_add_u32 m0, s57, 52224
  s_add_u32 s52, s58, 98304
  buffer_load_dwordx4 v233, s[24:27], s52 offen lds
  s_add_u32 m0, s57, 135168
  s_add_u32 s52, s59, 0
  buffer_load_dwordx4 v234, s[20:23], s52 offen lds
  s_add_u32 m0, s57, 136192
  s_add_u32 s52, s59, 9216
  buffer_load_dwordx4 v235, s[20:23], s52 offen lds
  s_add_u32 m0, s57, 137216
  s_add_u32 s52, s59, 18432
  buffer_load_dwordx4 v234, s[20:23], s52 offen lds
  s_add_u32 m0, s57, 138240
  s_add_u32 s52, s59, 27648
  buffer_load_dwordx4 v235, s[20:23], s52 offen lds
  s_add_u32 m0, s61, 135168
  s_add_u32 s62, s62, 1
  buffer_load_dwordx4 v231, s[20:23], s60 offen lds
  s_cmp_eq_u32 s62, 9
  s_cselect_b32 s62, 0, s62
  s_cselect_b32 s52, -16, 2
  s_lshl_b32 s52, s52, 6
  s_add_u32 s59, s59, s52
  s_add_u32 s60, s60, s52
  s_lshl_b32 s52, s52, 12
  s_add_u32 s58, s58, s52
  s_waitcnt vmcnt(9)
  s_barrier
  s_add_u32 m0, s57, 83968
  s_add_u32 s52, s58, 0
  buffer_load_dwordx4 v232, s[24:27], s52 offen lds
  s_add_u32 m0, s57, 84992
  s_add_u32 s52, s58, 32768
  buffer_load_dwordx4 v232, s[24:27], s52 offen lds
  s_add_u32 m0, s57, 86016
  s_add_u32 s52, s58, 65536
  buffer_load_dwordx4 v233, s[24:27], s52 offen lds
  s_add_u32 m0, s57, 87040
  s_add_u32 s52, s58, 98304
  buffer_load_dwordx4 v233, s[24:27], s52 offen lds
  s_add_u32 m0, s57, 65536
  s_add_u32 s52, s59, 0
  buffer_load_dwordx4 v234, s[20:23], s52 offen lds
  s_add_u32 m0, s57, 66560
  s_add_u32 s52, s59, 9216
  buffer_load_dwordx4 v235, s[20:23], s52 offen lds
  s_add_u32 m0, s57, 67584
  s_add_u32 s52, s59, 18432
  buffer_load_dwordx4 v234, s[20:23], s52 offen lds
  s_add_u32 m0, s57, 68608
  s_add_u32 s52, s59, 27648
  buffer_load_dwordx4 v235, s[20:23], s52 offen lds
  s_add_u32 m0, s61, 65536
  s_add_u32 s62, s62, 1
  buffer_load_dwordx4 v231, s[20:23], s60 offen lds
  s_cmp_eq_u32 s62, 9
  s_cselect_b32 s62, 0, s62
  s_cselect_b32 s52, -16, 2
  s_lshl_b32 s52, s52, 6
  s_add_u32 s59, s59, s52
  s_add_u32 s60, s60, s52
  s_lshl_b32 s52, s52, 12
  s_add_u32 s58, s58, s52
  s_waitcnt vmcnt(9)
  s_barrier
  s_add_u32 m0, s57, 118784
  s_add_u32 s52, s58, 0
  buffer_load_dwordx4 v232, s[24:27], s52 offen lds
  s_add_u32 m0, s57, 119808
  s_add_u32 s52, s58, 32768
  buffer_load_dwordx4 v232, s[24:27], s52 offen lds
  s_add_u32 m0, s57, 120832
  s_add_u32 s52, s58, 65536
  buffer_load_dwordx4 v233, s[24:27], s52 offen lds
  s_add_u32 m0, s57, 121856
  s_add_u32 s52, s58, 98304
  buffer_load_dwordx4 v233, s[24:27], s52 offen lds
  s_add_u32 m0, s57, 100352
  s_add_u32 s52, s59, 0
  buffer_load_dwordx4 v234, s[20:23], s52 offen lds
  s_add_u32 m0, s57, 101376
  s_add_u32 s52, s59, 9216
  buffer_load_dwordx4 v235, s[20:23], s52 offen lds
  s_add_u32 m0, s57, 102400
  s_add_u32 s52, s59, 18432
  buffer_load_dwordx4 v234, s[20:23], s52 offen lds
  s_add_u32 m0, s57, 103424
  s_add_u32 s52, s59, 27648
  buffer_load_dwordx4 v235, s[20:23], s52 offen lds
  s_add_u32 m0, s61, 100352
  s_add_u32 s62, s62, 1
  buffer_load_dwordx4 v231, s[20:23], s60 offen lds
  s_cmp_eq_u32 s62, 9
  s_cselect_b32 s62, 0, s62
  s_cselect_b32 s52, -16, 2
  s_lshl_b32 s52, s52, 6
  s_add_u32 s59, s59, s52
  s_add_u32 s60, s60, s52
  s_lshl_b32 s52, s52, 12
  s_add_u32 s58, s58, s52
  s_waitcnt vmcnt(9)
  s_barrier
  s_add_u32 m0, s57, 49152
  s_add_u32 s52, s58, 0
  buffer_load_dwordx4 v232, s[24:27], s52 offen lds
  s_add_u32 m0, s57, 50176
  s_add_u32 s52, s58, 32768
  buffer_load_dwordx4 v232, s[24:27], s52 offen lds
  s_add_u32 m0, s57, 51200
  s_add_u32 s52, s58, 65536
  buffer_load_dwordx4 v233, s[24:27], s52 offen lds
  s_add_u32 m0, s57, 52224
  s_add_u32 s52, s58, 98304
  buffer_load_dwordx4 v233, s[24:27], s52 offen lds
  s_add_u32 m0, s57, 135168
  s_add_u32 s52, s59, 0
  buffer_load_dwordx4 v234, s[20:23], s52 offen lds
  s_add_u32 m0, s57, 136192
  s_add_u32 s52, s59, 9216
  buffer_load_dwordx4 v235, s[20:23], s52 offen lds
  s_add_u32 m0, s57, 137216
  s_add_u32 s52, s59, 18432
  buffer_load_dwordx4 v234, s[20:23], s52 offen lds
  s_add_u32 m0, s57, 138240
  s_add_u32 s52, s59, 27648
  buffer_load_dwordx4 v235, s[20:23], s52 offen lds
  s_add_u32 m0, s61, 135168
  s_add_u32 s62, s62, 1
  buffer_load_dwordx4 v231, s[20:23], s60 offen lds
  s_cmp_eq_u32 s62, 9
  s_cselect_b32 s62, 0, s62
  s_cselect_b32 s52, -16, 2
  s_lshl_b32 s52, s52, 6
  s_add_u32 s59, s59, s52
  s_add_u32 s60, s60, s52
  s_lshl_b32 s52, s52, 12
  s_add_u32 s58, s58, s52
  s_waitcnt vmcnt(9)
  s_barrier
  s_cmp_lg_u32 s43, 1
  s_cbranch_scc1 L_p0nk
  s_mov_b32 s45, -2
  s_add_u32 s52, s45, 2
  s_and_b32 s53, s52, 3
  s_lshl_b32 s53, s53, 14
  s_lshl_b32 s52, s52, 13
  s_add_u32 s54, s52, 4096
  s_add_u32 m0, s53, 0
  s_nop 0
  buffer_load_dwordx4 v132, s[28:31], s52 offen offset:0 nt lds
  buffer_load_dwordx4 v133, s[28:31], s52 offen offset:1024 nt lds
  buffer_load_dwordx4 v134, s[28:31], s52 offen offset:2048 nt lds
  buffer_load_dwordx4 v135, s[28:31], s52 offen offset:3072 nt lds
  s_add_u32 m0, s53, 4096
  s_nop 0
  buffer_load_dwordx4 v132, s[28:31], s54 offen offset:0 nt lds
  buffer_load_dwordx4 v133, s[28:31], s54 offen offset:1024 nt lds
  buffer_load_dwordx4 v134, s[28:31], s54 offen offset:2048 nt lds
  buffer_load_dwordx4 v135, s[28:31], s54 offen offset:3072 nt lds
  s_add_u32 m0, s53, 8192
  s_nop 0
  buffer_load_dwordx4 v136, s[32:35], s52 offen offset:0 nt lds
  buffer_load_dwordx4 v137, s[32:35], s52 offen offset:1024 nt lds
  buffer_load_dwordx4 v136, s[32:35], s52 offen offset:2048 nt lds
  buffer_load_dwordx4 v137, s[32:35], s52 offen offset:3072 nt lds
  s_add_u32 m0, s53, 12288
  s_nop 0
  buffer_load_dwordx4 v136, s[32:35], s54 offen offset:0 nt lds
  buffer_load_dwordx4 v137, s[32:35], s54 offen offset:1024 nt lds
  buffer_load_dwordx4 v136, s[32:35], s54 offen offset:2048 nt lds
  buffer_load_dwordx4 v137, s[32:35], s54 offen offset:3072 nt lds
  s_branch L_p0k
L_p0nk:
  s_and_b32 s52, s55, 7
  s_mul_i32 s52, s52, 589824
  s_add_u32 s52, s52, 256
  s_max_u32 s53, s43, 1
  s_sub_u32 s53, s53, 1
  s_mul_i32 s53, s53, 196608
  s_add_u32 s52, s52, s53
  v_lshrrev_b32 v212, 3, v0
  v_lshlrev_b32 v212, 13, v212
  v_and_b32 v213, 7, v0
  v_lshl_add_u32 v212, v213, 5, v212
  buffer_load_dword v252, v212, s[24:27], s52 offen
  s_add_u32 s52, s52, 65536
  buffer_load_dword v252, v212, s[24:27], s52 offen
  s_add_u32 s52, s52, 65536
  buffer_load_dword v252, v212, s[24:27], s52 offen
  s_add_u32 s52, s52, 65536
L_p0k:
  s_cmp_eq_u32 s43, 1
  s_cbranch_scc1 L_p0w8
  s_waitcnt vmcnt(3)
L_p0w8:
  s_waitcnt vmcnt(16)
  s_barrier
  s_cmp_lg_u32 s43, 1
  s_cbranch_scc1 L_p0m
  s_mov_b32 s45, -1
  s_add_u32 s52, s45, 2
  s_and_b32 s53, s52, 3
  s_lshl_b32 s53, s53, 14
  s_lshl_b32 s52, s52, 13
  s_add_u32 s54, s52, 4096
  s_add_u32 m0, s53, 0
  s_nop 0
  buffer_load_dwordx4 v132, s[28:31], s52 offen offset:0 nt lds
  buffer_load_dwordx4 v133, s[28:31], s52 offen offset:1024 nt lds
  buffer_load_dwordx4 v134, s[28:31], s52 offen offset:2048 nt lds
  buffer_load_dwordx4 v135, s[28:31], s52 offen offset:3072 nt lds
  s_add_u32 m0, s53, 4096
  s_nop 0
  buffer_load_dwordx4 v132, s[28:31], s54 offen offset:0 nt lds
  buffer_load_dwordx4 v133, s[28:31], s54 offen offset:1024 nt lds
  buffer_load_dwordx4 v134, s[28:31], s54 offen offset:2048 nt lds
  buffer_load_dwordx4 v135, s[28:31], s54 offen offset:3072 nt lds
  s_add_u32 m0, s53, 8192
  s_nop 0
  buffer_load_dwordx4 v136, s[32:35], s52 offen offset:0 nt lds
  buffer_load_dwordx4 v137, s[32:35], s52 offen offset:1024 nt lds
  buffer_load_dwordx4 v136, s[32:35], s52 offen offset:2048 nt lds
  buffer_load_dwordx4 v137, s[32:35], s52 offen offset:3072 nt lds
  s_add_u32 m0, s53, 12288
  s_nop 0
  buffer_load_dwordx4 v136, s[32:35], s54 offen offset:0 nt lds
  buffer_load_dwordx4 v137, s[32:35], s54 offen offset:1024 nt lds
  buffer_load_dwordx4 v136, s[32:35], s54 offen offset:2048 nt lds
  buffer_load_dwordx4 v137, s[32:35], s54 offen offset:3072 nt lds
L_p0m:
  s_barrier
  s_cmp_eq_u32 s43, 1
  s_cbranch_scc1 L_lrole
  s_cmp_eq_u32 s43, 3
  s_cbranch_scc1 L_qb
  v_lshlrev_b32 v2, 2, v0
  v_add_u32 v2, 163328, v2
  s_cmp_lg_u32 s43, 0
  s_cbranch_scc1 L_yswitch
  v_mov_b32 v215, 163680
  v_mov_b32 v214, 0
  s_mov_b64 exec, 1
  buffer_load_dword v212, v214, s[88:91], 0 offen
L_gettag:
  s_waitcnt vmcnt(0)
  v_cmp_ne_u32 vcc, 0, v212
  s_cbranch_vccnz L_gottag
  s_add_u32 s99, s99, 1
  s_cmp_gt_u32 s99, 0x40000
  s_cbranch_scc1 L_end
  s_sleep 8
  buffer_load_dword v212, v214, s[88:91], 0 offen sc1
  s_branch L_gettag
L_gottag:
  ds_write_b32 v215, v212 offset:0
  s_mov_b64 exec, -1
  s_branch L_yswitch
L_x_p0:
  v_add_u32 v212, 0, v3
  v_xor_b32 v212, v212, v2
  v_lshlrev_b32 v212, 4, v212
  v_lshl_add_u32 v236, v2, 8, v212
  v_add_u32 v212, 4, v3
  v_xor_b32 v212, v212, v2
  v_lshlrev_b32 v212, 4, v212
  v_lshl_add_u32 v237, v2, 8, v212
  v_add_u32 v212, 8, v3
  v_xor_b32 v212, v212, v2
  v_lshlrev_b32 v212, 4, v212
  v_lshl_add_u32 v238, v2, 8, v212
  v_add_u32 v212, 12, v3
  v_xor_b32 v212, v212, v2
  v_lshlrev_b32 v212, 4, v212
  v_lshl_add_u32 v239, v2, 8, v212
  v_lshrrev_b32 v214, 2, v2
  v_lshl_add_u32 v212, v3, 2, v214
  v_and_b32 v215, 3, v0
  v_lshlrev_b32 v215, 3, v215
  v_lshl_add_u32 v213, v212, 8, v215
  v_add_u32 v213, 8192, v213
  v_and_b32 v212, 7, v212
  v_xor_b32 v216, 0, v212
  v_lshl_add_u32 v240, v216, 5, v213
  v_xor_b32 v216, 1, v212
  v_lshl_add_u32 v241, v216, 5, v213
  v_xor_b32 v216, 2, v212
  v_lshl_add_u32 v242, v216, 5, v213
  v_xor_b32 v216, 3, v212
  v_lshl_add_u32 v243, v216, 5, v213
  v_xor_b32 v216, 4, v212
  v_lshl_add_u32 v244, v216, 5, v213
  v_xor_b32 v216, 5, v212
  v_lshl_add_u32 v245, v216, 5, v213
  v_xor_b32 v216, 6, v212
  v_lshl_add_u32 v246, v216, 5, v213
  v_xor_b32 v216, 7, v212
  v_lshl_add_u32 v247, v216, 5, v213
  v_mov_b32 v4, 163584
  v_mov_b32 v128, 0x3f803f80
  v_mov_b32 v129, 0x3f803f80
  v_mov_b32 v130, 0x3f803f80
  v_mov_b32 v131, 0x3f803f80
  v_lshrrev_b32 v218, 2, v2
  v_lshl_add_u32 v216, v3, 3, v218
  v_lshlrev_b32 v216, 8, v216
  v_and_b32 v217, 3, v0
  v_lshl_add_u32 v216, v217, 3, v216
  v_add_u32 v216, 83968, v216
  v_and_b32 v217, 1, v3
  v_lshl_add_u32 v217, v217, 2, v218
  s_lshl_b32 s52, s43, 1
  v_xor_b32 v217, s52, v217
  v_lshl_add_u32 v212, v217, 5, v216
  v_xor_b32 v213, 32, v212
  v_lshrrev_b32 v216, 1, v2
  v_xor_b32 v216, v216, v3
  v_lshlrev_b32 v216, 4, v216
  v_lshl_add_u32 v216, v2, 7, v216
  v_add_u32 v214, 65536, v216
  v_xor_b32 v215, 64, v214
  v_mov_b64 v[8:9], 0
  v_mov_b64 v[10:11], 0
  v_mov_b64 v[12:13], 0
  v_mov_b64 v[14:15], 0
  v_mov_b64 v[16:17], 0
  v_mov_b64 v[18:19], 0
  v_mov_b64 v[20:21], 0
  v_mov_b64 v[22:23], 0
  v_mov_b64 v[24:25], 0
  v_mov_b64 v[26:27], 0
  v_mov_b64 v[28:29], 0
  v_mov_b64 v[30:31], 0
  v_mov_b64 v[32:33], 0
  v_mov_b64 v[34:35], 0
  v_mov_b64 v[36:37], 0
  v_mov_b64 v[38:39], 0
  v_mov_b64 v[40:41], 0
  v_mov_b64 v[42:43], 0
  v_mov_b64 v[44:45], 0
  v_mov_b64 v[46:47], 0
  v_mov_b64 v[48:49], 0
  v_mov_b64 v[50:51], 0
  v_mov_b64 v[52:53], 0
  v_mov_b64 v[54:55], 0
  v_mov_b64 v[56:57], 0
  v_mov_b64 v[58:59], 0
  v_mov_b64 v[60:61], 0
  v_mov_b64 v[62:63], 0
  v_mov_b64 v[64:65], 0
  v_mov_b64 v[66:67], 0
  v_mov_b64 v[68:69], 0
  v_mov_b64 v[70:71], 0
  v_mov_b64 v[72:73], 0
  v_mov_b64 v[74:75], 0
  v_mov_b64 v[76:77], 0
  v_mov_b64 v[78:79], 0
  v_mov_b64 v[176:177], 0
  v_mov_b64 v[178:179], 0
  v_mov_b64 v[180:181], 0
  v_mov_b64 v[182:183], 0
  v_mov_b64 v[184:185], 0
  v_mov_b64 v[186:187], 0
  v_mov_b64 v[188:189], 0
  v_mov_b64 v[190:191], 0
  v_mov_b64 v[192:193], 0
  v_mov_b64 v[194:195], 0
  v_mov_b64 v[196:197], 0
  v_mov_b64 v[198:199], 0
  v_mov_b64 v[200:201], 0
  v_mov_b64 v[202:203], 0
  v_mov_b64 v[204:205], 0
  v_mov_b64 v[206:207], 0
  v_mov_b64 v[208:209], 0
  v_mov_b64 v[210:211], 0
  v_mov_b64 v[88:89], 0
  v_mov_b64 v[90:91], 0
  v_mov_b64 v[92:93], 0
  v_mov_b64 v[94:95], 0
  s_mov_b32 s61, 0
L_qploop:
  s_waitcnt lgkmcnt(0)
  s_barrier
  v_mfma_f32_16x16x32_bf16 v[8:11], v[88:91], v[176:179], v[8:11]
  v_mfma_f32_16x16x32_bf16 v[12:15], v[92:95], v[176:179], v[12:15]
  ds_read_b64_tr_b16 v[168:169], v212 offset:0
  v_mfma_f32_16x16x32_bf16 v[16:19], v[88:91], v[180:183], v[16:19]
  ds_read_b64_tr_b16 v[170:171], v212 offset:1024
  v_mfma_f32_16x16x32_bf16 v[20:23], v[92:95], v[180:183], v[20:23]
  ds_read_b64_tr_b16 v[172:173], v213 offset:0
  v_mfma_f32_16x16x32_bf16 v[24:27], v[88:91], v[184:187], v[24:27]
  ds_read_b64_tr_b16 v[174:175], v213 offset:1024
  v_mfma_f32_16x16x32_bf16 v[28:31], v[92:95], v[184:187], v[28:31]
  ds_read_b128 v[132:135], v214 offset:0
  v_mfma_f32_16x16x32_bf16 v[32:35], v[88:91], v[188:191], v[32:35]
  ds_read_b128 v[136:139], v214 offset:2048
  v_mfma_f32_16x16x32_bf16 v[36:39], v[92:95], v[188:191], v[36:39]
  ds_read_b128 v[140:143], v214 offset:4096
  v_mfma_f32_16x16x32_bf16 v[40:43], v[88:91], v[192:195], v[40:43]
  ds_read_b128 v[144:147], v214 offset:6144
  v_mfma_f32_16x16x32_bf16 v[44:47], v[92:95], v[192:195], v[44:47]
  ds_read_b128 v[148:151], v214 offset:8192
  v_mfma_f32_16x16x32_bf16 v[48:51], v[88:91], v[196:199], v[48:51]
  ds_read_b128 v[152:155], v214 offset:10240
  v_mfma_f32_16x16x32_bf16 v[52:55], v[92:95], v[196:199], v[52:55]
  ds_read_b128 v[156:159], v214 offset:12288
  v_mfma_f32_16x16x32_bf16 v[56:59], v[88:91], v[200:203], v[56:59]
  ds_read_b128 v[160:163], v214 offset:14336
  v_mfma_f32_16x16x32_bf16 v[60:63], v[92:95], v[200:203], v[60:63]
  ds_read_b128 v[164:167], v214 offset:16384
  v_mfma_f32_16x16x32_bf16 v[64:67], v[88:91], v[204:207], v[64:67]
  v_mfma_f32_16x16x32_bf16 v[68:71], v[92:95], v[204:207], v[68:71]
  v_mfma_f32_16x16x32_bf16 v[72:75], v[88:91], v[208:211], v[72:75]
  v_mfma_f32_16x16x32_bf16 v[76:79], v[92:95], v[208:211], v[76:79]
  s_waitcnt lgkmcnt(3)
  v_mfma_f32_16x16x32_bf16 v[8:11], v[168:171], v[132:135], v[8:11]
  v_mfma_f32_16x16x32_bf16 v[12:15], v[172:175], v[132:135], v[12:15]
  ds_read_b64_tr_b16 v[88:89], v212 offset:8192
  v_mfma_f32_16x16x32_bf16 v[16:19], v[168:171], v[136:139], v[16:19]
  ds_read_b64_tr_b16 v[90:91], v212 offset:9216
  v_mfma_f32_16x16x32_bf16 v[20:23], v[172:175], v[136:139], v[20:23]
  ds_read_b64_tr_b16 v[92:93], v213 offset:8192
  v_mfma_f32_16x16x32_bf16 v[24:27], v[168:171], v[140:143], v[24:27]
  ds_read_b64_tr_b16 v[94:95], v213 offset:9216
  v_mfma_f32_16x16x32_bf16 v[28:31], v[172:175], v[140:143], v[28:31]
  ds_read_b128 v[176:179], v215 offset:0
  v_mfma_f32_16x16x32_bf16 v[32:35], v[168:171], v[144:147], v[32:35]
  ds_read_b128 v[180:183], v215 offset:2048
  v_mfma_f32_16x16x32_bf16 v[36:39], v[172:175], v[144:147], v[36:39]
  ds_read_b128 v[184:187], v215 offset:4096
  v_mfma_f32_16x16x32_bf16 v[40:43], v[168:171], v[148:151], v[40:43]
  ds_read_b128 v[188:191], v215 offset:6144
  v_mfma_f32_16x16x32_bf16 v[44:47], v[172:175], v[148:151], v[44:47]
  ds_read_b128 v[192:195], v215 offset:8192
  v_mfma_f32_16x16x32_bf16 v[48:51], v[168:171], v[152:155], v[48:51]
  ds_read_b128 v[196:199], v215 offset:10240
  v_mfma_f32_16x16x32_bf16 v[52:55], v[172:175], v[152:155], v[52:55]
  ds_read_b128 v[200:203], v215 offset:12288
  s_waitcnt lgkmcnt(5)
  v_mfma_f32_16x16x32_bf16 v[56:59], v[168:171], v[156:159], v[56:59]
  ds_read_b128 v[204:207], v215 offset:14336
  v_mfma_f32_16x16x32_bf16 v[60:63], v[172:175], v[156:159], v[60:63]
  ds_read_b128 v[208:211], v215 offset:16384
  v_mfma_f32_16x16x32_bf16 v[64:67], v[168:171], v[160:163], v[64:67]
  v_add_u32 v214, 34816, v214
  v_mfma_f32_16x16x32_bf16 v[68:71], v[172:175], v[160:163], v[68:71]
  v_add_u32 v215, 34816, v215
  v_mfma_f32_16x16x32_bf16 v[72:75], v[168:171], v[164:167], v[72:75]
  v_add_u32 v212, 34816, v212
  v_mfma_f32_16x16x32_bf16 v[76:79], v[172:175], v[164:167], v[76:79]
  v_add_u32 v213, 34816, v213
  s_waitcnt lgkmcnt(0)
  s_barrier
  v_mfma_f32_16x16x32_bf16 v[8:11], v[88:91], v[176:179], v[8:11]
  v_mfma_f32_16x16x32_bf16 v[12:15], v[92:95], v[176:179], v[12:15]
  ds_read_b64_tr_b16 v[168:169], v212 offset:0
  v_mfma_f32_16x16x32_bf16 v[16:19], v[88:91], v[180:183], v[16:19]
  ds_read_b64_tr_b16 v[170:171], v212 offset:1024
  v_mfma_f32_16x16x32_bf16 v[20:23], v[92:95], v[180:183], v[20:23]
  ds_read_b64_tr_b16 v[172:173], v213 offset:0
  v_mfma_f32_16x16x32_bf16 v[24:27], v[88:91], v[184:187], v[24:27]
  ds_read_b64_tr_b16 v[174:175], v213 offset:1024
  v_mfma_f32_16x16x32_bf16 v[28:31], v[92:95], v[184:187], v[28:31]
  ds_read_b128 v[132:135], v214 offset:0
  v_mfma_f32_16x16x32_bf16 v[32:35], v[88:91], v[188:191], v[32:35]
  ds_read_b128 v[136:139], v214 offset:2048
  v_mfma_f32_16x16x32_bf16 v[36:39], v[92:95], v[188:191], v[36:39]
  ds_read_b128 v[140:143], v214 offset:4096
  v_mfma_f32_16x16x32_bf16 v[40:43], v[88:91], v[192:195], v[40:43]
  ds_read_b128 v[144:147], v214 offset:6144
  v_mfma_f32_16x16x32_bf16 v[44:47], v[92:95], v[192:195], v[44:47]
  ds_read_b128 v[148:151], v214 offset:8192
  v_mfma_f32_16x16x32_bf16 v[48:51], v[88:91], v[196:199], v[48:51]
  ds_read_b128 v[152:155], v214 offset:10240
  v_mfma_f32_16x16x32_bf16 v[52:55], v[92:95], v[196:199], v[52:55]
  ds_read_b128 v[156:159], v214 offset:12288
  v_mfma_f32_16x16x32_bf16 v[56:59], v[88:91], v[200:203], v[56:59]
  ds_read_b128 v[160:163], v214 offset:14336
  v_mfma_f32_16x16x32_bf16 v[60:63], v[92:95], v[200:203], v[60:63]
  ds_read_b128 v[164:167], v214 offset:16384
  v_mfma_f32_16x16x32_bf16 v[64:67], v[88:91], v[204:207], v[64:67]
  v_mfma_f32_16x16x32_bf16 v[68:71], v[92:95], v[204:207], v[68:71]
  v_mfma_f32_16x16x32_bf16 v[72:75], v[88:91], v[208:211], v[72:75]
  v_mfma_f32_16x16x32_bf16 v[76:79], v[92:95], v[208:211], v[76:79]
  s_waitcnt lgkmcnt(3)
  v_mfma_f32_16x16x32_bf16 v[8:11], v[168:171], v[132:135], v[8:11]
  v_mfma_f32_16x16x32_bf16 v[12:15], v[172:175], v[132:135], v[12:15]
  ds_read_b64_tr_b16 v[88:89], v212 offset:8192
  v_mfma_f32_16x16x32_bf16 v[16:19], v[168:171], v[136:139], v[16:19]
  ds_read_b64_tr_b16 v[90:91], v212 offset:9216
  v_mfma_f32_16x16x32_bf16 v[20:23], v[172:175], v[136:139], v[20:23]
  ds_read_b64_tr_b16 v[92:93], v213 offset:8192
  v_mfma_f32_16x16x32_bf16 v[24:27], v[168:171], v[140:143], v[24:27]
  ds_read_b64_tr_b16 v[94:95], v213 offset:9216
  v_mfma_f32_16x16x32_bf16 v[28:31], v[172:175], v[140:143], v[28:31]
  ds_read_b128 v[176:179], v215 offset:0
  v_mfma_f32_16x16x32_bf16 v[32:35], v[168:171], v[144:147], v[32:35]
  ds_read_b128 v[180:183], v215 offset:2048
  v_mfma_f32_16x16x32_bf16 v[36:39], v[172:175], v[144:147], v[36:39]
  ds_read_b128 v[184:187], v215 offset:4096
  v_mfma_f32_16x16x32_bf16 v[40:43], v[168:171], v[148:151], v[40:43]
  ds_read_b128 v[188:191], v215 offset:6144
  v_mfma_f32_16x16x32_bf16 v[44:47], v[172:175], v[148:151], v[44:47]
  ds_read_b128 v[192:195], v215 offset:8192
  v_mfma_f32_16x16x32_bf16 v[48:51], v[168:171], v[152:155], v[48:51]
  ds_read_b128 v[196:199], v215 offset:10240
  v_mfma_f32_16x16x32_bf16 v[52:55], v[172:175], v[152:155], v[52:55]
  ds_read_b128 v[200:203], v215 offset:12288
  s_waitcnt lgkmcnt(5)
  v_mfma_f32_16x16x32_bf16 v[56:59], v[168:171], v[156:159], v[56:59]
  ds_read_b128 v[204:207], v215 offset:14336
  v_mfma_f32_16x16x32_bf16 v[60:63], v[172:175], v[156:159], v[60:63]
  ds_read_b128 v[208:211], v215 offset:16384
  v_mfma_f32_16x16x32_bf16 v[64:67], v[168:171], v[160:163], v[64:67]
  v_add_u32 v214, 34816, v214
  v_mfma_f32_16x16x32_bf16 v[68:71], v[172:175], v[160:163], v[68:71]
  v_add_u32 v215, 34816, v215
  v_mfma_f32_16x16x32_bf16 v[72:75], v[168:171], v[164:167], v[72:75]
  v_add_u32 v212, 4294897664, v212
  v_mfma_f32_16x16x32_bf16 v[76:79], v[172:175], v[164:167], v[76:79]
  v_add_u32 v213, 4294897664, v213
  s_waitcnt lgkmcnt(0)
  s_barrier
  v_mfma_f32_16x16x32_bf16 v[8:11], v[88:91], v[176:179], v[8:11]
  v_mfma_f32_16x16x32_bf16 v[12:15], v[92:95], v[176:179], v[12:15]
  ds_read_b64_tr_b16 v[168:169], v212 offset:0
  v_mfma_f32_16x16x32_bf16 v[16:19], v[88:91], v[180:183], v[16:19]
  ds_read_b64_tr_b16 v[170:171], v212 offset:1024
  v_mfma_f32_16x16x32_bf16 v[20:23], v[92:95], v[180:183], v[20:23]
  ds_read_b64_tr_b16 v[172:173], v213 offset:0
  v_mfma_f32_16x16x32_bf16 v[24:27], v[88:91], v[184:187], v[24:27]
  ds_read_b64_tr_b16 v[174:175], v213 offset:1024
  v_mfma_f32_16x16x32_bf16 v[28:31], v[92:95], v[184:187], v[28:31]
  ds_read_b128 v[132:135], v214 offset:0
  v_mfma_f32_16x16x32_bf16 v[32:35], v[88:91], v[188:191], v[32:35]
  ds_read_b128 v[136:139], v214 offset:2048
  v_mfma_f32_16x16x32_bf16 v[36:39], v[92:95], v[188:191], v[36:39]
  ds_read_b128 v[140:143], v214 offset:4096
  v_mfma_f32_16x16x32_bf16 v[40:43], v[88:91], v[192:195], v[40:43]
  ds_read_b128 v[144:147], v214 offset:6144
  v_mfma_f32_16x16x32_bf16 v[44:47], v[92:95], v[192:195], v[44:47]
  ds_read_b128 v[148:151], v214 offset:8192
  v_mfma_f32_16x16x32_bf16 v[48:51], v[88:91], v[196:199], v[48:51]
  ds_read_b128 v[152:155], v214 offset:10240
  v_mfma_f32_16x16x32_bf16 v[52:55], v[92:95], v[196:199], v[52:55]
  ds_read_b128 v[156:159], v214 offset:12288
  v_mfma_f32_16x16x32_bf16 v[56:59], v[88:91], v[200:203], v[56:59]
  ds_read_b128 v[160:163], v214 offset:14336
  v_mfma_f32_16x16x32_bf16 v[60:63], v[92:95], v[200:203], v[60:63]
  ds_read_b128 v[164:167], v214 offset:16384
  v_mfma_f32_16x16x32_bf16 v[64:67], v[88:91], v[204:207], v[64:67]
  v_mfma_f32_16x16x32_bf16 v[68:71], v[92:95], v[204:207], v[68:71]
  v_mfma_f32_16x16x32_bf16 v[72:75], v[88:91], v[208:211], v[72:75]
  v_mfma_f32_16x16x32_bf16 v[76:79], v[92:95], v[208:211], v[76:79]
  s_waitcnt lgkmcnt(3)
  v_mfma_f32_16x16x32_bf16 v[8:11], v[168:171], v[132:135], v[8:11]
  v_mfma_f32_16x16x32_bf16 v[12:15], v[172:175], v[132:135], v[12:15]
  ds_read_b64_tr_b16 v[88:89], v212 offset:8192
  v_mfma_f32_16x16x32_bf16 v[16:19], v[168:171], v[136:139], v[16:19]
  ds_read_b64_tr_b16 v[90:91], v212 offset:9216
  v_mfma_f32_16x16x32_bf16 v[20:23], v[172:175], v[136:139], v[20:23]
  ds_read_b64_tr_b16 v[92:93], v213 offset:8192
  v_mfma_f32_16x16x32_bf16 v[24:27], v[168:171], v[140:143], v[24:27]
  ds_read_b64_tr_b16 v[94:95], v213 offset:9216
  v_mfma_f32_16x16x32_bf16 v[28:31], v[172:175], v[140:143], v[28:31]
  ds_read_b128 v[176:179], v215 offset:0
  v_mfma_f32_16x16x32_bf16 v[32:35], v[168:171], v[144:147], v[32:35]
  ds_read_b128 v[180:183], v215 offset:2048
  v_mfma_f32_16x16x32_bf16 v[36:39], v[172:175], v[144:147], v[36:39]
  ds_read_b128 v[184:187], v215 offset:4096
  v_mfma_f32_16x16x32_bf16 v[40:43], v[168:171], v[148:151], v[40:43]
  ds_read_b128 v[188:191], v215 offset:6144
  v_mfma_f32_16x16x32_bf16 v[44:47], v[172:175], v[148:151], v[44:47]
  ds_read_b128 v[192:195], v215 offset:8192
  v_mfma_f32_16x16x32_bf16 v[48:51], v[168:171], v[152:155], v[48:51]
  ds_read_b128 v[196:199], v215 offset:10240
  v_mfma_f32_16x16x32_bf16 v[52:55], v[172:175], v[152:155], v[52:55]
  ds_read_b128 v[200:203], v215 offset:12288
  s_waitcnt lgkmcnt(5)
  v_mfma_f32_16x16x32_bf16 v[56:59], v[168:171], v[156:159], v[56:59]
  ds_read_b128 v[204:207], v215 offset:14336
  v_mfma_f32_16x16x32_bf16 v[60:63], v[172:175], v[156:159], v[60:63]
  ds_read_b128 v[208:211], v215 offset:16384
  v_mfma_f32_16x16x32_bf16 v[64:67], v[168:171], v[160:163], v[64:67]
  v_add_u32 v214, 4294897664, v214
  v_mfma_f32_16x16x32_bf16 v[68:71], v[172:175], v[160:163], v[68:71]
  v_add_u32 v215, 4294897664, v215
  v_mfma_f32_16x16x32_bf16 v[72:75], v[168:171], v[164:167], v[72:75]
  v_add_u32 v212, 34816, v212
  v_mfma_f32_16x16x32_bf16 v[76:79], v[172:175], v[164:167], v[76:79]
  v_add_u32 v213, 34816, v213
  s_add_u32 s61, s61, 1
  s_cmp_lt_u32 s61, 3
  s_cbranch_scc1 L_qploop
  s_waitcnt lgkmcnt(0)
  v_mfma_f32_16x16x32_bf16 v[8:11], v[88:91], v[176:179], v[8:11]
  v_mfma_f32_16x16x32_bf16 v[12:15], v[92:95], v[176:179], v[12:15]
  v_mfma_f32_16x16x32_bf16 v[16:19], v[88:91], v[180:183], v[16:19]
  v_mfma_f32_16x16x32_bf16 v[20:23], v[92:95], v[180:183], v[20:23]
  v_mfma_f32_16x16x32_bf16 v[24:27], v[88:91], v[184:187], v[24:27]
  v_mfma_f32_16x16x32_bf16 v[28:31], v[92:95], v[184:187], v[28:31]
  v_mfma_f32_16x16x32_bf16 v[32:35], v[88:91], v[188:191], v[32:35]
  v_mfma_f32_16x16x32_bf16 v[36:39], v[92:95], v[188:191], v[36:39]
  v_mfma_f32_16x16x32_bf16 v[40:43], v[88:91], v[192:195], v[40:43]
  v_mfma_f32_16x16x32_bf16 v[44:47], v[92:95], v[192:195], v[44:47]
  v_mfma_f32_16x16x32_bf16 v[48:51], v[88:91], v[196:199], v[48:51]
  v_mfma_f32_16x16x32_bf16 v[52:55], v[92:95], v[196:199], v[52:55]
  v_mfma_f32_16x16x32_bf16 v[56:59], v[88:91], v[200:203], v[56:59]
  v_mfma_f32_16x16x32_bf16 v[60:63], v[92:95], v[200:203], v[60:63]
  v_mfma_f32_16x16x32_bf16 v[64:67], v[88:91], v[204:207], v[64:67]
  v_mfma_f32_16x16x32_bf16 v[68:71], v[92:95], v[204:207], v[68:71]
  v_mfma_f32_16x16x32_bf16 v[72:75], v[88:91], v[208:211], v[72:75]
  v_mfma_f32_16x16x32_bf16 v[76:79], v[92:95], v[208:211], v[76:79]
  s_lshl_b32 s52, s43, 10
  s_add_u32 s52, s52, 98304
  v_lshrrev_b32 v212, 1, v3
  v_lshl_add_u32 v212, v212, 4, v2
  v_lshlrev_b32 v212, 4, v212
  v_and_b32 v213, 1, v3
  v_lshl_add_u32 v212, v213, 3, v212
  v_add_u32 v212, s52, v212
  v_pk_mul_f32 v[8:9], v[8:9], s[64:65]
  v_pk_mul_f32 v[10:11], v[10:11], s[64:65]
  v_pk_mul_f32 v[12:13], v[12:13], s[64:65]
  v_pk_mul_f32 v[14:15], v[14:15], s[64:65]
  v_cvt_pk_bf16_f32 v132, v8, v9
  v_cvt_pk_bf16_f32 v133, v10, v11
  v_cvt_pk_bf16_f32 v134, v12, v13
  v_cvt_pk_bf16_f32 v135, v14, v15
  ds_write_b64 v212, v[132:133] offset:0
  ds_write_b64 v212, v[134:135] offset:512
  v_pk_mul_f32 v[16:17], v[16:17], s[64:65]
  v_pk_mul_f32 v[18:19], v[18:19], s[64:65]
  v_pk_mul_f32 v[20:21], v[20:21], s[64:65]
  v_pk_mul_f32 v[22:23], v[22:23], s[64:65]
  v_cvt_pk_bf16_f32 v136, v16, v17
  v_cvt_pk_bf16_f32 v137, v18, v19
  v_cvt_pk_bf16_f32 v138, v20, v21
  v_cvt_pk_bf16_f32 v139, v22, v23
  ds_write_b64 v212, v[136:137] offset:4096
  ds_write_b64 v212, v[138:139] offset:4608
  v_pk_mul_f32 v[24:25], v[24:25], s[64:65]
  v_pk_mul_f32 v[26:27], v[26:27], s[64:65]
  v_pk_mul_f32 v[28:29], v[28:29], s[64:65]
  v_pk_mul_f32 v[30:31], v[30:31], s[64:65]
  v_cvt_pk_bf16_f32 v140, v24, v25
  v_cvt_pk_bf16_f32 v141, v26, v27
  v_cvt_pk_bf16_f32 v142, v28, v29
  v_cvt_pk_bf16_f32 v143, v30, v31
  ds_write_b64 v212, v[140:141] offset:8192
  ds_write_b64 v212, v[142:143] offset:8704
  v_pk_mul_f32 v[32:33], v[32:33], s[64:65]
  v_pk_mul_f32 v[34:35], v[34:35], s[64:65]
  v_pk_mul_f32 v[36:37], v[36:37], s[64:65]
  v_pk_mul_f32 v[38:39], v[38:39], s[64:65]
  v_cvt_pk_bf16_f32 v144, v32, v33
  v_cvt_pk_bf16_f32 v145, v34, v35
  v_cvt_pk_bf16_f32 v146, v36, v37
  v_cvt_pk_bf16_f32 v147, v38, v39
  ds_write_b64 v212, v[144:145] offset:12288
  ds_write_b64 v212, v[146:147] offset:12800
  v_pk_mul_f32 v[40:41], v[40:41], s[64:65]
  v_pk_mul_f32 v[42:43], v[42:43], s[64:65]
  v_pk_mul_f32 v[44:45], v[44:45], s[64:65]
  v_pk_mul_f32 v[46:47], v[46:47], s[64:65]
  v_cvt_pk_bf16_f32 v148, v40, v41
  v_cvt_pk_bf16_f32 v149, v42, v43
  v_cvt_pk_bf16_f32 v150, v44, v45
  v_cvt_pk_bf16_f32 v151, v46, v47
  ds_write_b64 v212, v[148:149] offset:16384
  ds_write_b64 v212, v[150:151] offset:16896
  v_pk_mul_f32 v[48:49], v[48:49], s[64:65]
  v_pk_mul_f32 v[50:51], v[50:51], s[64:65]
  v_pk_mul_f32 v[52:53], v[52:53], s[64:65]
  v_pk_mul_f32 v[54:55], v[54:55], s[64:65]
  v_cvt_pk_bf16_f32 v152, v48, v49
  v_cvt_pk_bf16_f32 v153, v50, v51
  v_cvt_pk_bf16_f32 v154, v52, v53
  v_cvt_pk_bf16_f32 v155, v54, v55
  ds_write_b64 v212, v[152:153] offset:20480
  ds_write_b64 v212, v[154:155] offset:20992
  v_pk_mul_f32 v[56:57], v[56:57], s[64:65]
  v_pk_mul_f32 v[58:59], v[58:59], s[64:65]
  v_pk_mul_f32 v[60:61], v[60:61], s[64:65]
  v_pk_mul_f32 v[62:63], v[62:63], s[64:65]
  v_cvt_pk_bf16_f32 v156, v56, v57
  v_cvt_pk_bf16_f32 v157, v58, v59
  v_cvt_pk_bf16_f32 v158, v60, v61
  v_cvt_pk_bf16_f32 v159, v62, v63
  ds_write_b64 v212, v[156:157] offset:24576
  ds_write_b64 v212, v[158:159] offset:25088
  v_pk_mul_f32 v[64:65], v[64:65], s[64:65]
  v_pk_mul_f32 v[66:67], v[66:67], s[64:65]
  v_pk_mul_f32 v[68:69], v[68:69], s[64:65]
  v_pk_mul_f32 v[70:71], v[70:71], s[64:65]
  v_cvt_pk_bf16_f32 v160, v64, v65
  v_cvt_pk_bf16_f32 v161, v66, v67
  v_cvt_pk_bf16_f32 v162, v68, v69
  v_cvt_pk_bf16_f32 v163, v70, v71
  ds_write_b64 v212, v[160:161] offset:28672
  ds_write_b64 v212, v[162:163] offset:29184
  v_pk_mul_f32 v[72:73], v[72:73], s[64:65]
  v_pk_mul_f32 v[74:75], v[74:75], s[64:65]
  v_pk_mul_f32 v[76:77], v[76:77], s[64:65]
  v_pk_mul_f32 v[78:79], v[78:79], s[64:65]
  v_cvt_pk_bf16_f32 v164, v72, v73
  v_cvt_pk_bf16_f32 v165, v74, v75
  v_cvt_pk_bf16_f32 v166, v76, v77
  v_cvt_pk_bf16_f32 v167, v78, v79
  ds_write_b64 v212, v[164:165] offset:32768
  ds_write_b64 v212, v[166:167] offset:33280
  v_mov_b64 v[8:9], 0
  v_mov_b64 v[10:11], 0
  v_mov_b64 v[12:13], 0
  v_mov_b64 v[14:15], 0
  v_mov_b64 v[16:17], 0
  v_mov_b64 v[18:19], 0
  v_mov_b64 v[20:21], 0
  v_mov_b64 v[22:23], 0
  v_mov_b64 v[24:25], 0
  v_mov_b64 v[26:27], 0
  v_mov_b64 v[28:29], 0
  v_mov_b64 v[30:31], 0
  v_mov_b64 v[32:33], 0
  v_mov_b64 v[34:35], 0
  v_mov_b64 v[36:37], 0
  v_mov_b64 v[38:39], 0
  v_mov_b64 v[40:41], 0
  v_mov_b64 v[42:43], 0
  v_mov_b64 v[44:45], 0
  v_mov_b64 v[46:47], 0
  v_mov_b64 v[48:49], 0
  v_mov_b64 v[50:51], 0
  v_mov_b64 v[52:53], 0
  v_mov_b64 v[54:55], 0
  v_mov_b64 v[56:57], 0
  v_mov_b64 v[58:59], 0
  v_mov_b64 v[60:61], 0
  v_mov_b64 v[62:63], 0
  v_mov_b64 v[64:65], 0
  v_mov_b64 v[66:67], 0
  v_mov_b64 v[68:69], 0
  v_mov_b64 v[70:71], 0
  v_mov_b64 v[72:73], 0
  v_mov_b64 v[74:75], 0
  v_mov_b64 v[76:77], 0
  v_mov_b64 v[78:79], 0
  v_mov_b64 v[80:81], 0
  v_mov_b64 v[82:83], 0
  v_mov_b64 v[84:85], 0
  v_mov_b64 v[86:87], 0
  v_mov_b64 v[88:89], 0
  v_mov_b64 v[90:91], 0
  v_mov_b64 v[92:93], 0
  v_mov_b64 v[94:95], 0
  v_mov_b64 v[96:97], 0
  v_mov_b64 v[98:99], 0
  v_mov_b64 v[100:101], 0
  v_mov_b64 v[102:103], 0
  v_mov_b64 v[104:105], 0
  v_mov_b64 v[106:107], 0
  v_mov_b64 v[108:109], 0
  v_mov_b64 v[110:111], 0
  v_mov_b64 v[112:113], 0
  v_mov_b64 v[114:115], 0
  v_mov_b64 v[116:117], 0
  v_mov_b64 v[118:119], 0
  v_mov_b64 v[120:121], 0
  v_mov_b64 v[122:123], 0
  v_mov_b64 v[124:125], 0
  v_mov_b64 v[126:127], 0
  s_mov_b32 s48, 0xff800000
  s_mov_b32 s51, 0xff800000
  s_mov_b32 s49, 0xff800000
  s_mov_b32 s66, 0xff800000
  s_mov_b32 s50, 0xff800000
  s_mov_b32 s67, 0xff800000
  s_waitcnt lgkmcnt(0)
  s_barrier
  s_cmp_eq_u32 s43, 3
  s_cbranch_scc1 L_qb
  s_mul_i32 s52, s43, 12288
  s_add_u32 s52, s52, 98304
  v_lshl_add_u32 v212, v0, 4, s52
  ds_read_b128 v[132:135], v212 offset:0
  ds_read_b128 v[136:139], v212 offset:1024
  ds_read_b128 v[140:143], v212 offset:2048
  ds_read_b128 v[144:147], v212 offset:3072
  ds_read_b128 v[148:151], v212 offset:4096
  ds_read_b128 v[152:155], v212 offset:5120
  ds_read_b128 v[156:159], v212 offset:6144
  ds_read_b128 v[160:163], v212 offset:7168
  ds_read_b128 v[164:167], v212 offset:8192
  ds_read_b128 v[168:171], v212 offset:9216
  ds_read_b128 v[172:175], v212 offset:10240
  ds_read_b128 v[176:179], v212 offset:11264
  s_mov_b32 s45, 0
  s_mov_b32 s46, 32
  v_mov_b32 v254, 0
  s_lshl_b32 s52, s43, 2
  s_add_u32 s52, s52, 163600
  v_lshlrev_b32 v255, 2, v0
  v_add_u32 v255, 163328, v255
    v_writelane_b32 v255, s52, 0
  s_nop 0
  v_lshlrev_b32 v2, 2, v0
  v_add_u32 v2, 163328, v2
L_astart:
  s_setprio 2
L_afirst:
  ds_read_b32 v253, v4 offset:0
  s_waitcnt lgkmcnt(0)
  v_cmp_lt_u32 vcc, s45, v253
  s_cbranch_vccnz L_afirst_ok
  s_add_u32 s99, s99, 1
  s_cmp_gt_u32 s99, 0x40000
  s_cbranch_scc1 L_end
  s_sleep 1
  s_branch L_afirst
L_afirst_ok:
  ds_read_b128 v[180:183], v236 offset:0
  ds_read_b128 v[184:187], v237 offset:0
  ds_read_b128 v[188:191], v238 offset:0
  ds_read_b128 v[192:195], v239 offset:0
  ds_read_b128 v[196:199], v236 offset:4096
  ds_read_b128 v[200:203], v237 offset:4096
  ds_read_b128 v[204:207], v238 offset:4096
  ds_read_b128 v[208:211], v239 offset:4096
L_abody0:
  s_waitcnt lgkmcnt(7)
  v_mfma_f32_16x16x32_bf16 v[212:215], v[180:183], v[132:135], v[116:119]
  s_waitcnt lgkmcnt(6)
  v_mfma_f32_16x16x32_bf16 v[212:215], v[184:187], v[136:139], v[212:215]
  v_add_u32 v254, 1, v254
  s_waitcnt lgkmcnt(5)
  v_mfma_f32_16x16x32_bf16 v[212:215], v[188:191], v[140:143], v[212:215]
  s_add_u32 s45, s45, 1
  s_waitcnt lgkmcnt(4)
  v_mfma_f32_16x16x32_bf16 v[212:215], v[192:195], v[144:147], v[212:215]
  s_sub_u32 s63, s46, 1
  s_waitcnt lgkmcnt(3)
  v_mfma_f32_16x16x32_bf16 v[216:219], v[196:199], v[132:135], v[116:119]
  s_min_u32 s63, s63, s45
  s_waitcnt lgkmcnt(2)
  v_mfma_f32_16x16x32_bf16 v[216:219], v[200:203], v[136:139], v[216:219]
  v_mov_b32 v5, 34
  s_waitcnt lgkmcnt(1)
  v_mfma_f32_16x16x32_bf16 v[216:219], v[204:207], v[140:143], v[216:219]
  s_waitcnt lgkmcnt(0)
  v_mfma_f32_16x16x32_bf16 v[216:219], v[208:211], v[144:147], v[216:219]
  v_mfma_f32_16x16x32_bf16 v[220:223], v[180:183], v[148:151], v[120:123]
  v_mfma_f32_16x16x32_bf16 v[220:223], v[184:187], v[152:155], v[220:223]
  v_max3_f32 v248, v212, v213, v214
  s_nop 4
  v_max3_f32 v248, v248, v215, v216
  v_mfma_f32_16x16x32_bf16 v[220:223], v[188:191], v[156:159], v[220:223]
  v_max3_f32 v248, v248, v217, v218
  v_max_f32 v248, v248, v219
  v_mfma_f32_16x16x32_bf16 v[220:223], v[192:195], v[160:163], v[220:223]
  v_cmp_lt_f32 vcc, s48, v248
  v_mfma_f32_16x16x32_bf16 v[224:227], v[196:199], v[148:151], v[120:123]
  s_cbranch_vccnz L_stuba0_0
L_backa0_0:
  v_exp_f32 v212, v212
  v_exp_f32 v213, v213
  v_mfma_f32_16x16x32_bf16 v[224:227], v[200:203], v[152:155], v[224:227]
  v_exp_f32 v214, v214
  v_exp_f32 v215, v215
  v_cvt_pk_bf16_f32 v212, v212, v213
  v_mfma_f32_16x16x32_bf16 v[224:227], v[204:207], v[156:159], v[224:227]
  v_exp_f32 v216, v216
  v_exp_f32 v217, v217
  v_mfma_f32_16x16x32_bf16 v[224:227], v[208:211], v[160:163], v[224:227]
  v_cvt_pk_bf16_f32 v213, v214, v215
  v_exp_f32 v218, v218
  v_exp_f32 v219, v219
  v_mfma_f32_16x16x32_bf16 v[228:231], v[180:183], v[164:167], v[124:127]
  v_cvt_pk_bf16_f32 v214, v216, v217
  v_cvt_pk_bf16_f32 v215, v218, v219
  ds_read_b64_tr_b16 v[180:181], v240 offset:0
  ds_read_b64_tr_b16 v[182:183], v240 offset:4096
  v_mfma_f32_16x16x32_bf16 v[228:231], v[184:187], v[168:171], v[228:231]
  ds_read_b64_tr_b16 v[184:185], v241 offset:0
  ds_read_b64_tr_b16 v[186:187], v241 offset:4096
  v_mfma_f32_16x16x32_bf16 v[228:231], v[188:191], v[172:175], v[228:231]
  ds_read_b64_tr_b16 v[188:189], v242 offset:0
  ds_read_b64_tr_b16 v[190:191], v242 offset:4096
  v_mfma_f32_16x16x32_bf16 v[228:231], v[192:195], v[176:179], v[228:231]
  ds_read_b64_tr_b16 v[192:193], v243 offset:0
  ds_read_b64_tr_b16 v[194:195], v243 offset:4096
  v_mfma_f32_16x16x32_bf16 v[232:235], v[196:199], v[164:167], v[124:127]
  ds_read_b64_tr_b16 v[196:197], v244 offset:0
  ds_read_b64_tr_b16 v[198:199], v244 offset:4096
  v_mfma_f32_16x16x32_bf16 v[232:235], v[200:203], v[168:171], v[232:235]
  ds_read_b64_tr_b16 v[200:201], v245 offset:0
  ds_read_b64_tr_b16 v[202:203], v245 offset:4096
  v_mfma_f32_16x16x32_bf16 v[232:235], v[204:207], v[172:175], v[232:235]
  v_max3_f32 v249, v220, v221, v222
  v_max3_f32 v249, v249, v223, v224
  ds_read_b64_tr_b16 v[204:205], v246 offset:0
  ds_read_b64_tr_b16 v[206:207], v246 offset:4096
  v_mfma_f32_16x16x32_bf16 v[232:235], v[208:211], v[176:179], v[232:235]
  v_max3_f32 v249, v249, v225, v226
  v_max_f32 v249, v249, v227
  ds_read_b64_tr_b16 v[208:209], v247 offset:0
  ds_read_b64_tr_b16 v[210:211], v247 offset:4096
  v_mfma_f32_16x16x32_bf16 v[104:107], v[128:131], v[212:215], v[104:107]
  v_cmp_lt_f32 vcc, s49, v249
  s_waitcnt lgkmcnt(10)
  v_mfma_f32_16x16x32_bf16 v[8:11], v[180:183], v[212:215], v[8:11]
  s_cbranch_vccnz L_stuba0_1
L_backa0_1:
  v_exp_f32 v220, v220
  v_mfma_f32_16x16x32_bf16 v[12:15], v[184:187], v[212:215], v[12:15]
  v_exp_f32 v221, v221
  v_exp_f32 v222, v222
  v_mfma_f32_16x16x32_bf16 v[16:19], v[188:191], v[212:215], v[16:19]
  v_exp_f32 v223, v223
  v_cvt_pk_bf16_f32 v220, v220, v221
  s_waitcnt lgkmcnt(4)
  v_mfma_f32_16x16x32_bf16 v[20:23], v[192:195], v[212:215], v[20:23]
  v_exp_f32 v224, v224
  v_exp_f32 v225, v225
  v_mfma_f32_16x16x32_bf16 v[24:27], v[196:199], v[212:215], v[24:27]
  v_cvt_pk_bf16_f32 v221, v222, v223
  v_exp_f32 v226, v226
  v_mfma_f32_16x16x32_bf16 v[28:31], v[200:203], v[212:215], v[28:31]
  v_exp_f32 v227, v227
  v_cvt_pk_bf16_f32 v222, v224, v225
  s_waitcnt lgkmcnt(0)
  v_mfma_f32_16x16x32_bf16 v[32:35], v[204:207], v[212:215], v[32:35]
  v_cvt_pk_bf16_f32 v223, v226, v227
  v_mfma_f32_16x16x32_bf16 v[36:39], v[208:211], v[212:215], v[36:39]
  v_max3_f32 v248, v228, v229, v230
  v_max3_f32 v248, v248, v231, v232
  v_mfma_f32_16x16x32_bf16 v[108:111], v[128:131], v[220:223], v[108:111]
  v_max3_f32 v248, v248, v233, v234
  v_max_f32 v248, v248, v235
  s_waitcnt vmcnt(0)
  ds_max_u32 v2, v5
  v_mfma_f32_16x16x32_bf16 v[40:43], v[180:183], v[220:223], v[40:43]
  v_cmp_lt_f32 vcc, s50, v248
  ds_write_b32 v255, v254 offset:0
  v_mfma_f32_16x16x32_bf16 v[44:47], v[184:187], v[220:223], v[44:47]
  s_cbranch_vccnz L_stuba0_2
L_backa0_2:
  v_exp_f32 v228, v228
  v_exp_f32 v229, v229
  ds_read_b32 v253, v4 offset:0
  v_mfma_f32_16x16x32_bf16 v[48:51], v[188:191], v[220:223], v[48:51]
  v_exp_f32 v230, v230
  v_exp_f32 v231, v231
  v_mfma_f32_16x16x32_bf16 v[52:55], v[192:195], v[220:223], v[52:55]
  v_cvt_pk_bf16_f32 v228, v228, v229
  v_exp_f32 v232, v232
  v_mfma_f32_16x16x32_bf16 v[56:59], v[196:199], v[220:223], v[56:59]
  v_exp_f32 v233, v233
  v_cvt_pk_bf16_f32 v229, v230, v231
  v_mfma_f32_16x16x32_bf16 v[60:63], v[200:203], v[220:223], v[60:63]
  v_exp_f32 v234, v234
  v_exp_f32 v235, v235
  v_mfma_f32_16x16x32_bf16 v[64:67], v[204:207], v[220:223], v[64:67]
  v_cvt_pk_bf16_f32 v230, v232, v233
  v_cvt_pk_bf16_f32 v231, v234, v235
  v_mfma_f32_16x16x32_bf16 v[68:71], v[208:211], v[220:223], v[68:71]
  s_waitcnt lgkmcnt(0)
  v_cmp_ge_u32 vcc, s63, v253
  v_mfma_f32_16x16x32_bf16 v[112:115], v[128:131], v[228:231], v[112:115]
  s_cbranch_vccnz L_aspin0
L_ago0:
  v_mfma_f32_16x16x32_bf16 v[72:75], v[180:183], v[228:231], v[72:75]
  ds_read_b128 v[180:183], v236 offset:16384
  v_mfma_f32_16x16x32_bf16 v[76:79], v[184:187], v[228:231], v[76:79]
  ds_read_b128 v[184:187], v237 offset:16384
  v_mfma_f32_16x16x32_bf16 v[80:83], v[188:191], v[228:231], v[80:83]
  ds_read_b128 v[188:191], v238 offset:16384
  v_mfma_f32_16x16x32_bf16 v[84:87], v[192:195], v[228:231], v[84:87]
  ds_read_b128 v[192:195], v239 offset:16384
  v_mfma_f32_16x16x32_bf16 v[88:91], v[196:199], v[228:231], v[88:91]
  ds_read_b128 v[196:199], v236 offset:20480
  v_mfma_f32_16x16x32_bf16 v[92:95], v[200:203], v[228:231], v[92:95]
  ds_read_b128 v[200:203], v237 offset:20480
  v_mfma_f32_16x16x32_bf16 v[96:99], v[204:207], v[228:231], v[96:99]
  ds_read_b128 v[204:207], v238 offset:20480
  s_cmp_eq_u32 s45, s46
  v_mfma_f32_16x16x32_bf16 v[100:103], v[208:211], v[228:231], v[100:103]
  ds_read_b128 v[208:211], v239 offset:20480
  s_cbranch_scc1 L_a_done
L_abody1:
  s_waitcnt lgkmcnt(7)
  v_mfma_f32_16x16x32_bf16 v[212:215], v[180:183], v[132:135], v[116:119]
  s_waitcnt lgkmcnt(6)
  v_mfma_f32_16x16x32_bf16 v[212:215], v[184:187], v[136:139], v[212:215]
  v_add_u32 v254, 1, v254
  s_waitcnt lgkmcnt(5)
  v_mfma_f32_16x16x32_bf16 v[212:215], v[188:191], v[140:143], v[212:215]
  s_add_u32 s45, s45, 1
  s_waitcnt lgkmcnt(4)
  v_mfma_f32_16x16x32_bf16 v[212:215], v[192:195], v[144:147], v[212:215]
  s_sub_u32 s63, s46, 1
  s_waitcnt lgkmcnt(3)
  v_mfma_f32_16x16x32_bf16 v[216:219], v[196:199], v[132:135], v[116:119]
  s_min_u32 s63, s63, s45
  s_waitcnt lgkmcnt(2)
  v_mfma_f32_16x16x32_bf16 v[216:219], v[200:203], v[136:139], v[216:219]
  s_waitcnt lgkmcnt(1)
  v_mfma_f32_16x16x32_bf16 v[216:219], v[204:207], v[140:143], v[216:219]
  s_waitcnt lgkmcnt(0)
  v_mfma_f32_16x16x32_bf16 v[216:219], v[208:211], v[144:147], v[216:219]
  v_mfma_f32_16x16x32_bf16 v[220:223], v[180:183], v[148:151], v[120:123]
  v_mfma_f32_16x16x32_bf16 v[220:223], v[184:187], v[152:155], v[220:223]
  v_max3_f32 v248, v212, v213, v214
  s_nop 4
  v_max3_f32 v248, v248, v215, v216
  v_mfma_f32_16x16x32_bf16 v[220:223], v[188:191], v[156:159], v[220:223]
  v_max3_f32 v248, v248, v217, v218
  v_max_f32 v248, v248, v219
  v_mfma_f32_16x16x32_bf16 v[220:223], v[192:195], v[160:163], v[220:223]
  v_cmp_lt_f32 vcc, s48, v248
  v_mfma_f32_16x16x32_bf16 v[224:227], v[196:199], v[148:151], v[120:123]
  s_cbranch_vccnz L_stuba1_0
L_backa1_0:
  v_exp_f32 v212, v212
  v_exp_f32 v213, v213
  v_mfma_f32_16x16x32_bf16 v[224:227], v[200:203], v[152:155], v[224:227]
  v_exp_f32 v214, v214
  v_exp_f32 v215, v215
  v_cvt_pk_bf16_f32 v212, v212, v213
  v_mfma_f32_16x16x32_bf16 v[224:227], v[204:207], v[156:159], v[224:227]
  v_exp_f32 v216, v216
  v_exp_f32 v217, v217
  v_mfma_f32_16x16x32_bf16 v[224:227], v[208:211], v[160:163], v[224:227]
  v_cvt_pk_bf16_f32 v213, v214, v215
  v_exp_f32 v218, v218
  v_exp_f32 v219, v219
  v_mfma_f32_16x16x32_bf16 v[228:231], v[180:183], v[164:167], v[124:127]
  v_cvt_pk_bf16_f32 v214, v216, v217
  v_cvt_pk_bf16_f32 v215, v218, v219
  ds_read_b64_tr_b16 v[180:181], v240 offset:16384
  ds_read_b64_tr_b16 v[182:183], v240 offset:20480
  v_mfma_f32_16x16x32_bf16 v[228:231], v[184:187], v[168:171], v[228:231]
  ds_read_b64_tr_b16 v[184:185], v241 offset:16384
  ds_read_b64_tr_b16 v[186:187], v241 offset:20480
  v_mfma_f32_16x16x32_bf16 v[228:231], v[188:191], v[172:175], v[228:231]
  ds_read_b64_tr_b16 v[188:189], v242 offset:16384
  ds_read_b64_tr_b16 v[190:191], v242 offset:20480
  v_mfma_f32_16x16x32_bf16 v[228:231], v[192:195], v[176:179], v[228:231]
  ds_read_b64_tr_b16 v[192:193], v243 offset:16384
  ds_read_b64_tr_b16 v[194:195], v243 offset:20480
  v_mfma_f32_16x16x32_bf16 v[232:235], v[196:199], v[164:167], v[124:127]
  ds_read_b64_tr_b16 v[196:197], v244 offset:16384
  ds_read_b64_tr_b16 v[198:199], v244 offset:20480
  v_mfma_f32_16x16x32_bf16 v[232:235], v[200:203], v[168:171], v[232:235]
  ds_read_b64_tr_b16 v[200:201], v245 offset:16384
  ds_read_b64_tr_b16 v[202:203], v245 offset:20480
  v_mfma_f32_16x16x32_bf16 v[232:235], v[204:207], v[172:175], v[232:235]
  v_max3_f32 v249, v220, v221, v222
  v_max3_f32 v249, v249, v223, v224
  ds_read_b64_tr_b16 v[204:205], v246 offset:16384
  ds_read_b64_tr_b16 v[206:207], v246 offset:20480
  v_mfma_f32_16x16x32_bf16 v[232:235], v[208:211], v[176:179], v[232:235]
  v_max3_f32 v249, v249, v225, v226
  v_max_f32 v249, v249, v227
  ds_read_b64_tr_b16 v[208:209], v247 offset:16384
  ds_read_b64_tr_b16 v[210:211], v247 offset:20480
  v_mfma_f32_16x16x32_bf16 v[104:107], v[128:131], v[212:215], v[104:107]
  v_cmp_lt_f32 vcc, s49, v249
  s_waitcnt lgkmcnt(10)
  v_mfma_f32_16x16x32_bf16 v[8:11], v[180:183], v[212:215], v[8:11]
  s_cbranch_vccnz L_stuba1_1
L_backa1_1:
  v_exp_f32 v220, v220
  v_mfma_f32_16x16x32_bf16 v[12:15], v[184:187], v[212:215], v[12:15]
  v_exp_f32 v221, v221
  v_exp_f32 v222, v222
  v_mfma_f32_16x16x32_bf16 v[16:19], v[188:191], v[212:215], v[16:19]
  v_exp_f32 v223, v223
  v_cvt_pk_bf16_f32 v220, v220, v221
  s_waitcnt lgkmcnt(4)
  v_mfma_f32_16x16x32_bf16 v[20:23], v[192:195], v[212:215], v[20:23]
  v_exp_f32 v224, v224
  v_exp_f32 v225, v225
  v_mfma_f32_16x16x32_bf16 v[24:27], v[196:199], v[212:215], v[24:27]
  v_cvt_pk_bf16_f32 v221, v222, v223
  v_exp_f32 v226, v226
  v_mfma_f32_16x16x32_bf16 v[28:31], v[200:203], v[212:215], v[28:31]
  v_exp_f32 v227, v227
  v_cvt_pk_bf16_f32 v222, v224, v225
  s_waitcnt lgkmcnt(0)
  v_mfma_f32_16x16x32_bf16 v[32:35], v[204:207], v[212:215], v[32:35]
  v_cvt_pk_bf16_f32 v223, v226, v227
  v_mfma_f32_16x16x32_bf16 v[36:39], v[208:211], v[212:215], v[36:39]
  v_max3_f32 v248, v228, v229, v230
  v_max3_f32 v248, v248, v231, v232
  v_mfma_f32_16x16x32_bf16 v[108:111], v[128:131], v[220:223], v[108:111]
  v_max3_f32 v248, v248, v233, v234
  v_max_f32 v248, v248, v235
  v_mfma_f32_16x16x32_bf16 v[40:43], v[180:183], v[220:223], v[40:43]
  v_cmp_lt_f32 vcc, s50, v248
  ds_write_b32 v255, v254 offset:0
  v_mfma_f32_16x16x32_bf16 v[44:47], v[184:187], v[220:223], v[44:47]
  s_cbranch_vccnz L_stuba1_2
L_backa1_2:
  v_exp_f32 v228, v228
  v_exp_f32 v229, v229
  ds_read_b32 v253, v4 offset:0
  v_mfma_f32_16x16x32_bf16 v[48:51], v[188:191], v[220:223], v[48:51]
  v_exp_f32 v230, v230
  v_exp_f32 v231, v231
  v_mfma_f32_16x16x32_bf16 v[52:55], v[192:195], v[220:223], v[52:55]
  v_cvt_pk_bf16_f32 v228, v228, v229
  v_exp_f32 v232, v232
  v_mfma_f32_16x16x32_bf16 v[56:59], v[196:199], v[220:223], v[56:59]
  v_exp_f32 v233, v233
  v_cvt_pk_bf16_f32 v229, v230, v231
  v_mfma_f32_16x16x32_bf16 v[60:63], v[200:203], v[220:223], v[60:63]
  v_exp_f32 v234, v234
  v_exp_f32 v235, v235
  v_mfma_f32_16x16x32_bf16 v[64:67], v[204:207], v[220:223], v[64:67]
  v_cvt_pk_bf16_f32 v230, v232, v233
  v_cvt_pk_bf16_f32 v231, v234, v235
  v_mfma_f32_16x16x32_bf16 v[68:71], v[208:211], v[220:223], v[68:71]
  s_waitcnt lgkmcnt(0)
  v_cmp_ge_u32 vcc, s63, v253
  v_mfma_f32_16x16x32_bf16 v[112:115], v[128:131], v[228:231], v[112:115]
  s_cbranch_vccnz L_aspin1
L_ago1:
  v_mfma_f32_16x16x32_bf16 v[72:75], v[180:183], v[228:231], v[72:75]
  ds_read_b128 v[180:183], v236 offset:32768
  v_mfma_f32_16x16x32_bf16 v[76:79], v[184:187], v[228:231], v[76:79]
  ds_read_b128 v[184:187], v237 offset:32768
  v_mfma_f32_16x16x32_bf16 v[80:83], v[188:191], v[228:231], v[80:83]
  ds_read_b128 v[188:191], v238 offset:32768
  v_mfma_f32_16x16x32_bf16 v[84:87], v[192:195], v[228:231], v[84:87]
  ds_read_b128 v[192:195], v239 offset:32768
  v_mfma_f32_16x16x32_bf16 v[88:91], v[196:199], v[228:231], v[88:91]
  ds_read_b128 v[196:199], v236 offset:36864
  v_mfma_f32_16x16x32_bf16 v[92:95], v[200:203], v[228:231], v[92:95]
  ds_read_b128 v[200:203], v237 offset:36864
  v_mfma_f32_16x16x32_bf16 v[96:99], v[204:207], v[228:231], v[96:99]
  ds_read_b128 v[204:207], v238 offset:36864
  s_cmp_eq_u32 s45, s46
  v_mfma_f32_16x16x32_bf16 v[100:103], v[208:211], v[228:231], v[100:103]
  ds_read_b128 v[208:211], v239 offset:36864
  s_cbranch_scc1 L_a_done
L_abody2:
  s_waitcnt lgkmcnt(7)
  v_mfma_f32_16x16x32_bf16 v[212:215], v[180:183], v[132:135], v[116:119]
  s_waitcnt lgkmcnt(6)
  v_mfma_f32_16x16x32_bf16 v[212:215], v[184:187], v[136:139], v[212:215]
  v_add_u32 v254, 1, v254
  s_waitcnt lgkmcnt(5)
  v_mfma_f32_16x16x32_bf16 v[212:215], v[188:191], v[140:143], v[212:215]
  s_add_u32 s45, s45, 1
  s_waitcnt lgkmcnt(4)
  v_mfma_f32_16x16x32_bf16 v[212:215], v[192:195], v[144:147], v[212:215]
  s_sub_u32 s63, s46, 1
  s_waitcnt lgkmcnt(3)
  v_mfma_f32_16x16x32_bf16 v[216:219], v[196:199], v[132:135], v[116:119]
  s_min_u32 s63, s63, s45
  s_waitcnt lgkmcnt(2)
  v_mfma_f32_16x16x32_bf16 v[216:219], v[200:203], v[136:139], v[216:219]
  s_waitcnt lgkmcnt(1)
  v_mfma_f32_16x16x32_bf16 v[216:219], v[204:207], v[140:143], v[216:219]
  s_waitcnt lgkmcnt(0)
  v_mfma_f32_16x16x32_bf16 v[216:219], v[208:211], v[144:147], v[216:219]
  v_mfma_f32_16x16x32_bf16 v[220:223], v[180:183], v[148:151], v[120:123]
  v_mfma_f32_16x16x32_bf16 v[220:223], v[184:187], v[152:155], v[220:223]
  v_max3_f32 v248, v212, v213, v214
  s_nop 4
  v_max3_f32 v248, v248, v215, v216
  v_mfma_f32_16x16x32_bf16 v[220:223], v[188:191], v[156:159], v[220:223]
  v_max3_f32 v248, v248, v217, v218
  v_max_f32 v248, v248, v219
  v_mfma_f32_16x16x32_bf16 v[220:223], v[192:195], v[160:163], v[220:223]
  v_cmp_lt_f32 vcc, s48, v248
  v_mfma_f32_16x16x32_bf16 v[224:227], v[196:199], v[148:151], v[120:123]
  s_cbranch_vccnz L_stuba2_0
L_backa2_0:
  v_exp_f32 v212, v212
  v_exp_f32 v213, v213
  v_mfma_f32_16x16x32_bf16 v[224:227], v[200:203], v[152:155], v[224:227]
  v_exp_f32 v214, v214
  v_exp_f32 v215, v215
  v_cvt_pk_bf16_f32 v212, v212, v213
  v_mfma_f32_16x16x32_bf16 v[224:227], v[204:207], v[156:159], v[224:227]
  v_exp_f32 v216, v216
  v_exp_f32 v217, v217
  v_mfma_f32_16x16x32_bf16 v[224:227], v[208:211], v[160:163], v[224:227]
  v_cvt_pk_bf16_f32 v213, v214, v215
  v_exp_f32 v218, v218
  v_exp_f32 v219, v219
  v_mfma_f32_16x16x32_bf16 v[228:231], v[180:183], v[164:167], v[124:127]
  v_cvt_pk_bf16_f32 v214, v216, v217
  v_cvt_pk_bf16_f32 v215, v218, v219
  ds_read_b64_tr_b16 v[180:181], v240 offset:32768
  ds_read_b64_tr_b16 v[182:183], v240 offset:36864
  v_mfma_f32_16x16x32_bf16 v[228:231], v[184:187], v[168:171], v[228:231]
  ds_read_b64_tr_b16 v[184:185], v241 offset:32768
  ds_read_b64_tr_b16 v[186:187], v241 offset:36864
  v_mfma_f32_16x16x32_bf16 v[228:231], v[188:191], v[172:175], v[228:231]
  ds_read_b64_tr_b16 v[188:189], v242 offset:32768
  ds_read_b64_tr_b16 v[190:191], v242 offset:36864
  v_mfma_f32_16x16x32_bf16 v[228:231], v[192:195], v[176:179], v[228:231]
  ds_read_b64_tr_b16 v[192:193], v243 offset:32768
  ds_read_b64_tr_b16 v[194:195], v243 offset:36864
  v_mfma_f32_16x16x32_bf16 v[232:235], v[196:199], v[164:167], v[124:127]
  ds_read_b64_tr_b16 v[196:197], v244 offset:32768
  ds_read_b64_tr_b16 v[198:199], v244 offset:36864
  v_mfma_f32_16x16x32_bf16 v[232:235], v[200:203], v[168:171], v[232:235]
  ds_read_b64_tr_b16 v[200:201], v245 offset:32768
  ds_read_b64_tr_b16 v[202:203], v245 offset:36864
  v_mfma_f32_16x16x32_bf16 v[232:235], v[204:207], v[172:175], v[232:235]
  v_max3_f32 v249, v220, v221, v222
  v_max3_f32 v249, v249, v223, v224
  ds_read_b64_tr_b16 v[204:205], v246 offset:32768
  ds_read_b64_tr_b16 v[206:207], v246 offset:36864
  v_mfma_f32_16x16x32_bf16 v[232:235], v[208:211], v[176:179], v[232:235]
  v_max3_f32 v249, v249, v225, v226
  v_max_f32 v249, v249, v227
  ds_read_b64_tr_b16 v[208:209], v247 offset:32768
  ds_read_b64_tr_b16 v[210:211], v247 offset:36864
  v_mfma_f32_16x16x32_bf16 v[104:107], v[128:131], v[212:215], v[104:107]
  v_cmp_lt_f32 vcc, s49, v249
  s_waitcnt lgkmcnt(10)
  v_mfma_f32_16x16x32_bf16 v[8:11], v[180:183], v[212:215], v[8:11]
  s_cbranch_vccnz L_stuba2_1
L_backa2_1:
  v_exp_f32 v220, v220
  v_mfma_f32_16x16x32_bf16 v[12:15], v[184:187], v[212:215], v[12:15]
  v_exp_f32 v221, v221
  v_exp_f32 v222, v222
  v_mfma_f32_16x16x32_bf16 v[16:19], v[188:191], v[212:215], v[16:19]
  v_exp_f32 v223, v223
  v_cvt_pk_bf16_f32 v220, v220, v221
  s_waitcnt lgkmcnt(4)
  v_mfma_f32_16x16x32_bf16 v[20:23], v[192:195], v[212:215], v[20:23]
  v_exp_f32 v224, v224
  v_exp_f32 v225, v225
  v_mfma_f32_16x16x32_bf16 v[24:27], v[196:199], v[212:215], v[24:27]
  v_cvt_pk_bf16_f32 v221, v222, v223
  v_exp_f32 v226, v226
  v_mfma_f32_16x16x32_bf16 v[28:31], v[200:203], v[212:215], v[28:31]
  v_exp_f32 v227, v227
  v_cvt_pk_bf16_f32 v222, v224, v225
  s_waitcnt lgkmcnt(0)
  v_mfma_f32_16x16x32_bf16 v[32:35], v[204:207], v[212:215], v[32:35]
  v_cvt_pk_bf16_f32 v223, v226, v227
  v_mfma_f32_16x16x32_bf16 v[36:39], v[208:211], v[212:215], v[36:39]
  v_max3_f32 v248, v228, v229, v230
  v_max3_f32 v248, v248, v231, v232
  v_mfma_f32_16x16x32_bf16 v[108:111], v[128:131], v[220:223], v[108:111]
  v_max3_f32 v248, v248, v233, v234
  v_max_f32 v248, v248, v235
  v_mfma_f32_16x16x32_bf16 v[40:43], v[180:183], v[220:223], v[40:43]
  v_cmp_lt_f32 vcc, s50, v248
  ds_write_b32 v255, v254 offset:0
  v_mfma_f32_16x16x32_bf16 v[44:47], v[184:187], v[220:223], v[44:47]
  s_cbranch_vccnz L_stuba2_2
L_backa2_2:
  v_exp_f32 v228, v228
  v_exp_f32 v229, v229
  ds_read_b32 v253, v4 offset:0
  v_mfma_f32_16x16x32_bf16 v[48:51], v[188:191], v[220:223], v[48:51]
  v_exp_f32 v230, v230
  v_exp_f32 v231, v231
  v_mfma_f32_16x16x32_bf16 v[52:55], v[192:195], v[220:223], v[52:55]
  v_cvt_pk_bf16_f32 v228, v228, v229
  v_exp_f32 v232, v232
  v_mfma_f32_16x16x32_bf16 v[56:59], v[196:199], v[220:223], v[56:59]
  v_exp_f32 v233, v233
  v_cvt_pk_bf16_f32 v229, v230, v231
  v_mfma_f32_16x16x32_bf16 v[60:63], v[200:203], v[220:223], v[60:63]
  v_exp_f32 v234, v234
  v_exp_f32 v235, v235
  v_mfma_f32_16x16x32_bf16 v[64:67], v[204:207], v[220:223], v[64:67]
  v_cvt_pk_bf16_f32 v230, v232, v233
  v_cvt_pk_bf16_f32 v231, v234, v235
  v_mfma_f32_16x16x32_bf16 v[68:71], v[208:211], v[220:223], v[68:71]
  s_waitcnt lgkmcnt(0)
  v_cmp_ge_u32 vcc, s63, v253
  v_mfma_f32_16x16x32_bf16 v[112:115], v[128:131], v[228:231], v[112:115]
  s_cbranch_vccnz L_aspin2
L_ago2:
  v_mfma_f32_16x16x32_bf16 v[72:75], v[180:183], v[228:231], v[72:75]
  ds_read_b128 v[180:183], v236 offset:49152
  v_mfma_f32_16x16x32_bf16 v[76:79], v[184:187], v[228:231], v[76:79]
  ds_read_b128 v[184:187], v237 offset:49152
  v_mfma_f32_16x16x32_bf16 v[80:83], v[188:191], v[228:231], v[80:83]
  ds_read_b128 v[188:191], v238 offset:49152
  v_mfma_f32_16x16x32_bf16 v[84:87], v[192:195], v[228:231], v[84:87]
  ds_read_b128 v[192:195], v239 offset:49152
  v_mfma_f32_16x16x32_bf16 v[88:91], v[196:199], v[228:231], v[88:91]
  ds_read_b128 v[196:199], v236 offset:53248
  v_mfma_f32_16x16x32_bf16 v[92:95], v[200:203], v[228:231], v[92:95]
  ds_read_b128 v[200:203], v237 offset:53248
  v_mfma_f32_16x16x32_bf16 v[96:99], v[204:207], v[228:231], v[96:99]
  ds_read_b128 v[204:207], v238 offset:53248
  s_cmp_eq_u32 s45, s46
  v_mfma_f32_16x16x32_bf16 v[100:103], v[208:211], v[228:231], v[100:103]
  ds_read_b128 v[208:211], v239 offset:53248
  s_cbranch_scc1 L_a_done
L_abody3:
  s_waitcnt lgkmcnt(7)
  v_mfma_f32_16x16x32_bf16 v[212:215], v[180:183], v[132:135], v[116:119]
  s_waitcnt lgkmcnt(6)
  v_mfma_f32_16x16x32_bf16 v[212:215], v[184:187], v[136:139], v[212:215]
  v_add_u32 v254, 1, v254
  s_waitcnt lgkmcnt(5)
  v_mfma_f32_16x16x32_bf16 v[212:215], v[188:191], v[140:143], v[212:215]
  s_add_u32 s45, s45, 1
  s_waitcnt lgkmcnt(4)
  v_mfma_f32_16x16x32_bf16 v[212:215], v[192:195], v[144:147], v[212:215]
  s_sub_u32 s63, s46, 1
  s_waitcnt lgkmcnt(3)
  v_mfma_f32_16x16x32_bf16 v[216:219], v[196:199], v[132:135], v[116:119]
  s_min_u32 s63, s63, s45
  s_waitcnt lgkmcnt(2)
  v_mfma_f32_16x16x32_bf16 v[216:219], v[200:203], v[136:139], v[216:219]
  s_waitcnt lgkmcnt(1)
  v_mfma_f32_16x16x32_bf16 v[216:219], v[204:207], v[140:143], v[216:219]
  s_waitcnt lgkmcnt(0)
  v_mfma_f32_16x16x32_bf16 v[216:219], v[208:211], v[144:147], v[216:219]
  v_mfma_f32_16x16x32_bf16 v[220:223], v[180:183], v[148:151], v[120:123]
  v_mfma_f32_16x16x32_bf16 v[220:223], v[184:187], v[152:155], v[220:223]
  v_max3_f32 v248, v212, v213, v214
  s_nop 4
  v_max3_f32 v248, v248, v215, v216
  v_mfma_f32_16x16x32_bf16 v[220:223], v[188:191], v[156:159], v[220:223]
  v_max3_f32 v248, v248, v217, v218
  v_max_f32 v248, v248, v219
  v_mfma_f32_16x16x32_bf16 v[220:223], v[192:195], v[160:163], v[220:223]
  v_cmp_lt_f32 vcc, s48, v248
  v_mfma_f32_16x16x32_bf16 v[224:227], v[196:199], v[148:151], v[120:123]
  s_cbranch_vccnz L_stuba3_0
L_backa3_0:
  v_exp_f32 v212, v212
  v_exp_f32 v213, v213
  v_mfma_f32_16x16x32_bf16 v[224:227], v[200:203], v[152:155], v[224:227]
  v_exp_f32 v214, v214
  v_exp_f32 v215, v215
  v_cvt_pk_bf16_f32 v212, v212, v213
  v_mfma_f32_16x16x32_bf16 v[224:227], v[204:207], v[156:159], v[224:227]
  v_exp_f32 v216, v216
  v_exp_f32 v217, v217
  v_mfma_f32_16x16x32_bf16 v[224:227], v[208:211], v[160:163], v[224:227]
  v_cvt_pk_bf16_f32 v213, v214, v215
  v_exp_f32 v218, v218
  v_exp_f32 v219, v219
  v_mfma_f32_16x16x32_bf16 v[228:231], v[180:183], v[164:167], v[124:127]
  v_cvt_pk_bf16_f32 v214, v216, v217
  v_cvt_pk_bf16_f32 v215, v218, v219
  ds_read_b64_tr_b16 v[180:181], v240 offset:49152
  ds_read_b64_tr_b16 v[182:183], v240 offset:53248
  v_mfma_f32_16x16x32_bf16 v[228:231], v[184:187], v[168:171], v[228:231]
  ds_read_b64_tr_b16 v[184:185], v241 offset:49152
  ds_read_b64_tr_b16 v[186:187], v241 offset:53248
  v_mfma_f32_16x16x32_bf16 v[228:231], v[188:191], v[172:175], v[228:231]
  ds_read_b64_tr_b16 v[188:189], v242 offset:49152
  ds_read_b64_tr_b16 v[190:191], v242 offset:53248
  v_mfma_f32_16x16x32_bf16 v[228:231], v[192:195], v[176:179], v[228:231]
  ds_read_b64_tr_b16 v[192:193], v243 offset:49152
  ds_read_b64_tr_b16 v[194:195], v243 offset:53248
  v_mfma_f32_16x16x32_bf16 v[232:235], v[196:199], v[164:167], v[124:127]
  ds_read_b64_tr_b16 v[196:197], v244 offset:49152
  ds_read_b64_tr_b16 v[198:199], v244 offset:53248
  v_mfma_f32_16x16x32_bf16 v[232:235], v[200:203], v[168:171], v[232:235]
  ds_read_b64_tr_b16 v[200:201], v245 offset:49152
  ds_read_b64_tr_b16 v[202:203], v245 offset:53248
  v_mfma_f32_16x16x32_bf16 v[232:235], v[204:207], v[172:175], v[232:235]
  v_max3_f32 v249, v220, v221, v222
  v_max3_f32 v249, v249, v223, v224
  ds_read_b64_tr_b16 v[204:205], v246 offset:49152
  ds_read_b64_tr_b16 v[206:207], v246 offset:53248
  v_mfma_f32_16x16x32_bf16 v[232:235], v[208:211], v[176:179], v[232:235]
  v_max3_f32 v249, v249, v225, v226
  v_max_f32 v249, v249, v227
  ds_read_b64_tr_b16 v[208:209], v247 offset:49152
  ds_read_b64_tr_b16 v[210:211], v247 offset:53248
  v_mfma_f32_16x16x32_bf16 v[104:107], v[128:131], v[212:215], v[104:107]
  v_cmp_lt_f32 vcc, s49, v249
  s_waitcnt lgkmcnt(10)
  v_mfma_f32_16x16x32_bf16 v[8:11], v[180:183], v[212:215], v[8:11]
  s_cbranch_vccnz L_stuba3_1
L_backa3_1:
  v_exp_f32 v220, v220
  v_mfma_f32_16x16x32_bf16 v[12:15], v[184:187], v[212:215], v[12:15]
  v_exp_f32 v221, v221
  v_exp_f32 v222, v222
  v_mfma_f32_16x16x32_bf16 v[16:19], v[188:191], v[212:215], v[16:19]
  v_exp_f32 v223, v223
  v_cvt_pk_bf16_f32 v220, v220, v221
  s_waitcnt lgkmcnt(4)
  v_mfma_f32_16x16x32_bf16 v[20:23], v[192:195], v[212:215], v[20:23]
  v_exp_f32 v224, v224
  v_exp_f32 v225, v225
  v_mfma_f32_16x16x32_bf16 v[24:27], v[196:199], v[212:215], v[24:27]
  v_cvt_pk_bf16_f32 v221, v222, v223
  v_exp_f32 v226, v226
  v_mfma_f32_16x16x32_bf16 v[28:31], v[200:203], v[212:215], v[28:31]
  v_exp_f32 v227, v227
  v_cvt_pk_bf16_f32 v222, v224, v225
  s_waitcnt lgkmcnt(0)
  v_mfma_f32_16x16x32_bf16 v[32:35], v[204:207], v[212:215], v[32:35]
  v_cvt_pk_bf16_f32 v223, v226, v227
  v_mfma_f32_16x16x32_bf16 v[36:39], v[208:211], v[212:215], v[36:39]
  v_max3_f32 v248, v228, v229, v230
  v_max3_f32 v248, v248, v231, v232
  v_mfma_f32_16x16x32_bf16 v[108:111], v[128:131], v[220:223], v[108:111]
  v_max3_f32 v248, v248, v233, v234
  v_max_f32 v248, v248, v235
  v_mfma_f32_16x16x32_bf16 v[40:43], v[180:183], v[220:223], v[40:43]
  v_cmp_lt_f32 vcc, s50, v248
  ds_write_b32 v255, v254 offset:0
  v_mfma_f32_16x16x32_bf16 v[44:47], v[184:187], v[220:223], v[44:47]
  s_cbranch_vccnz L_stuba3_2
L_backa3_2:
  v_exp_f32 v228, v228
  v_exp_f32 v229, v229
  ds_read_b32 v253, v4 offset:0
  v_mfma_f32_16x16x32_bf16 v[48:51], v[188:191], v[220:223], v[48:51]
  v_exp_f32 v230, v230
  v_exp_f32 v231, v231
  v_mfma_f32_16x16x32_bf16 v[52:55], v[192:195], v[220:223], v[52:55]
  v_cvt_pk_bf16_f32 v228, v228, v229
  v_exp_f32 v232, v232
  v_mfma_f32_16x16x32_bf16 v[56:59], v[196:199], v[220:223], v[56:59]
  v_exp_f32 v233, v233
  v_cvt_pk_bf16_f32 v229, v230, v231
  v_mfma_f32_16x16x32_bf16 v[60:63], v[200:203], v[220:223], v[60:63]
  v_exp_f32 v234, v234
  v_exp_f32 v235, v235
  v_mfma_f32_16x16x32_bf16 v[64:67], v[204:207], v[220:223], v[64:67]
  v_cvt_pk_bf16_f32 v230, v232, v233
  v_cvt_pk_bf16_f32 v231, v234, v235
  v_mfma_f32_16x16x32_bf16 v[68:71], v[208:211], v[220:223], v[68:71]
  s_waitcnt lgkmcnt(0)
  v_cmp_ge_u32 vcc, s63, v253
  v_mfma_f32_16x16x32_bf16 v[112:115], v[128:131], v[228:231], v[112:115]
  s_cbranch_vccnz L_aspin3
L_ago3:
  v_mfma_f32_16x16x32_bf16 v[72:75], v[180:183], v[228:231], v[72:75]
  ds_read_b128 v[180:183], v236 offset:0
  v_mfma_f32_16x16x32_bf16 v[76:79], v[184:187], v[228:231], v[76:79]
  ds_read_b128 v[184:187], v237 offset:0
  v_mfma_f32_16x16x32_bf16 v[80:83], v[188:191], v[228:231], v[80:83]
  ds_read_b128 v[188:191], v238 offset:0
  v_mfma_f32_16x16x32_bf16 v[84:87], v[192:195], v[228:231], v[84:87]
  ds_read_b128 v[192:195], v239 offset:0
  v_mfma_f32_16x16x32_bf16 v[88:91], v[196:199], v[228:231], v[88:91]
  ds_read_b128 v[196:199], v236 offset:4096
  v_mfma_f32_16x16x32_bf16 v[92:95], v[200:203], v[228:231], v[92:95]
  ds_read_b128 v[200:203], v237 offset:4096
  v_mfma_f32_16x16x32_bf16 v[96:99], v[204:207], v[228:231], v[96:99]
  ds_read_b128 v[204:207], v238 offset:4096
  s_cmp_eq_u32 s45, s46
  v_mfma_f32_16x16x32_bf16 v[100:103], v[208:211], v[228:231], v[100:103]
  ds_read_b128 v[208:211], v239 offset:4096
  s_cbranch_scc1 L_a_done
  s_branch L_abody0
L_aspin0:
  s_add_u32 s99, s99, 1
  s_cmp_gt_u32 s99, 0x40000
  s_cbranch_scc1 L_end
  s_sleep 1
  ds_read_b32 v253, v4 offset:0
  s_waitcnt lgkmcnt(0)
  v_cmp_ge_u32 vcc, s63, v253
  s_cbranch_vccnz L_aspin0
  s_branch L_ago0
L_aspin1:
  s_add_u32 s99, s99, 1
  s_cmp_gt_u32 s99, 0x40000
  s_cbranch_scc1 L_end
  s_sleep 1
  ds_read_b32 v253, v4 offset:0
  s_waitcnt lgkmcnt(0)
  v_cmp_ge_u32 vcc, s63, v253
  s_cbranch_vccnz L_aspin1
  s_branch L_ago1
L_aspin2:
  s_add_u32 s99, s99, 1
  s_cmp_gt_u32 s99, 0x40000
  s_cbranch_scc1 L_end
  s_sleep 1
  ds_read_b32 v253, v4 offset:0
  s_waitcnt lgkmcnt(0)
  v_cmp_ge_u32 vcc, s63, v253
  s_cbranch_vccnz L_aspin2
  s_branch L_ago2
L_aspin3:
  s_add_u32 s99, s99, 1
  s_cmp_gt_u32 s99, 0x40000
  s_cbranch_scc1 L_end
  s_sleep 1
  ds_read_b32 v253, v4 offset:0
  s_waitcnt lgkmcnt(0)
  v_cmp_ge_u32 vcc, s63, v253
  s_cbranch_vccnz L_aspin3
  s_branch L_ago3
L_a_done:
  s_waitcnt lgkmcnt(0)
  v_and_b32 v2, 15, v0
  v_lshrrev_b32 v3, 4, v0
  s_cmp_lg_u32 s42, 1
  s_cbranch_scc1 L_aepi
  v_add_u32 v212, 0, v3
  v_xor_b32 v212, v212, v2
  v_lshlrev_b32 v212, 4, v212
  v_lshl_add_u32 v132, v3, 8, v212
  v_add_u32 v212, 4, v3
  v_xor_b32 v212, v212, v2
  v_lshlrev_b32 v212, 4, v212
  v_lshl_add_u32 v133, v3, 8, v212
  v_add_u32 v212, 8, v3
  v_xor_b32 v212, v212, v2
  v_lshlrev_b32 v212, 4, v212
  v_lshl_add_u32 v134, v3, 8, v212
  v_add_u32 v212, 12, v3
  v_xor_b32 v212, v212, v2
  v_lshlrev_b32 v212, 4, v212
  v_lshl_add_u32 v135, v3, 8, v212
  v_add_u32 v212, 0, v3
  v_lshlrev_b32 v212, 1, v212
  v_xor_b32 v212, v212, v2
  v_lshlrev_b32 v212, 4, v212
  v_lshl_add_u32 v136, v3, 8, v212
  v_add_u32 v212, 4, v3
  v_lshlrev_b32 v212, 1, v212
  v_xor_b32 v212, v212, v2
  v_lshlrev_b32 v212, 4, v212
  v_lshl_add_u32 v137, v3, 8, v212
  v_lshlrev_b32 v145, 2, v0
  v_add_u32 v145, 163328, v145
  s_mov_b32 s53, 163584
    v_writelane_b32 v145, s53, 0
  s_nop 0
  v_lshlrev_b32 v146, 2, v0
  v_add_u32 v146, 163328, v146
  s_mov_b32 s53, 163728
    v_writelane_b32 v146, s53, 0
  s_nop 0
  v_min_u32 v212, 7, v0
  v_lshlrev_b32 v138, 2, v212
  v_add_u32 v138, 163600, v138
  v_cmp_lt_u32 vcc, 2, v212
  v_mov_b32 v139, 0
  v_mov_b32 v140, 32
  v_cndmask_b32 v139, v139, 32, vcc
  v_cndmask_b32 v140, v140, 64, vcc
  v_cmp_lt_u32 vcc, 5, v212
  s_nop 1
  v_cndmask_b32 v139, v139, 0, vcc
  v_cndmask_b32 v140, v140, 0, vcc
  s_add_i32 s52, s45, -1
  v_med3_i32 v141, s52, v139, v140
L_x1c:
  ds_read_b32 v143, v138 offset:0
  s_waitcnt lgkmcnt(0)
  v_cmp_gt_u32 vcc, v141, v143
  s_cbranch_vccz L_x1c_ok
  s_add_u32 s99, s99, 1
  s_cmp_gt_u32 s99, 0x40000
  s_cbranch_scc1 L_end
  s_sleep 1
  s_branch L_x1c
L_x1c_ok:
  s_add_u32 s52, s45, 2
  s_and_b32 s53, s52, 3
  s_lshl_b32 s53, s53, 14
  s_lshl_b32 s52, s52, 13
  s_add_u32 s54, s52, 4096
  s_add_u32 m0, s53, 0
  s_nop 0
  buffer_load_dwordx4 v132, s[28:31], s52 offen offset:0 nt lds
  buffer_load_dwordx4 v133, s[28:31], s52 offen offset:1024 nt lds
  buffer_load_dwordx4 v134, s[28:31], s52 offen offset:2048 nt lds
  buffer_load_dwordx4 v135, s[28:31], s52 offen offset:3072 nt lds
  s_add_u32 m0, s53, 4096
  s_nop 0
  buffer_load_dwordx4 v132, s[28:31], s54 offen offset:0 nt lds
  buffer_load_dwordx4 v133, s[28:31], s54 offen offset:1024 nt lds
  buffer_load_dwordx4 v134, s[28:31], s54 offen offset:2048 nt lds
  buffer_load_dwordx4 v135, s[28:31], s54 offen offset:3072 nt lds
  s_add_u32 m0, s53, 8192
  s_nop 0
  buffer_load_dwordx4 v136, s[32:35], s52 offen offset:0 nt lds
  buffer_load_dwordx4 v137, s[32:35], s52 offen offset:1024 nt lds
  buffer_load_dwordx4 v136, s[32:35], s52 offen offset:2048 nt lds
  buffer_load_dwordx4 v137, s[32:35], s52 offen offset:3072 nt lds
  s_add_u32 m0, s53, 12288
  s_nop 0
  buffer_load_dwordx4 v136, s[32:35], s54 offen offset:0 nt lds
  buffer_load_dwordx4 v137, s[32:35], s54 offen offset:1024 nt lds
  buffer_load_dwordx4 v136, s[32:35], s54 offen offset:2048 nt lds
  buffer_load_dwordx4 v137, s[32:35], s54 offen offset:3072 nt lds
  s_setprio 3
L_aepi:
  v_rcp_f32 v116, v104
  v_rcp_f32 v120, v108
  v_rcp_f32 v124, v112
  v_mov_b32 v117, v116
  v_mov_b32 v121, v120
  v_mov_b32 v125, v124
  v_lshlrev_b32 v248, 4, v0
  v_pk_mul_f32 v[8:9], v[8:9], v[116:117]
  v_pk_mul_f32 v[10:11], v[10:11], v[116:117]
  v_pk_mul_f32 v[12:13], v[12:13], v[116:117]
  v_pk_mul_f32 v[14:15], v[14:15], v[116:117]
  v_pk_mul_f32 v[16:17], v[16:17], v[116:117]
  v_pk_mul_f32 v[18:19], v[18:19], v[116:117]
  v_pk_mul_f32 v[20:21], v[20:21], v[116:117]
  v_pk_mul_f32 v[22:23], v[22:23], v[116:117]
  v_pk_mul_f32 v[24:25], v[24:25], v[116:117]
  v_pk_mul_f32 v[26:27], v[26:27], v[116:117]
  v_pk_mul_f32 v[28:29], v[28:29], v[116:117]
  v_pk_mul_f32 v[30:31], v[30:31], v[116:117]
  v_pk_mul_f32 v[32:33], v[32:33], v[116:117]
  v_pk_mul_f32 v[34:35], v[34:35], v[116:117]
  v_pk_mul_f32 v[36:37], v[36:37], v[116:117]
  v_pk_mul_f32 v[38:39], v[38:39], v[116:117]
  v_cvt_pk_bf16_f32 v180, v8, v9
  v_cvt_pk_bf16_f32 v181, v10, v11
  v_cvt_pk_bf16_f32 v182, v12, v13
  v_cvt_pk_bf16_f32 v183, v14, v15
  v_cvt_pk_bf16_f32 v184, v16, v17
  v_cvt_pk_bf16_f32 v185, v18, v19
  v_cvt_pk_bf16_f32 v186, v20, v21
  v_cvt_pk_bf16_f32 v187, v22, v23
  v_cvt_pk_bf16_f32 v188, v24, v25
  v_cvt_pk_bf16_f32 v189, v26, v27
  v_cvt_pk_bf16_f32 v190, v28, v29
  v_cvt_pk_bf16_f32 v191, v30, v31
  v_cvt_pk_bf16_f32 v192, v32, v33
  v_cvt_pk_bf16_f32 v193, v34, v35
  v_cvt_pk_bf16_f32 v194, v36, v37
  v_cvt_pk_bf16_f32 v195, v38, v39
  v_pk_mul_f32 v[40:41], v[40:41], v[120:121]
  v_pk_mul_f32 v[42:43], v[42:43], v[120:121]
  v_pk_mul_f32 v[44:45], v[44:45], v[120:121]
  v_pk_mul_f32 v[46:47], v[46:47], v[120:121]
  v_pk_mul_f32 v[48:49], v[48:49], v[120:121]
  v_pk_mul_f32 v[50:51], v[50:51], v[120:121]
  v_pk_mul_f32 v[52:53], v[52:53], v[120:121]
  v_pk_mul_f32 v[54:55], v[54:55], v[120:121]
  v_pk_mul_f32 v[56:57], v[56:57], v[120:121]
  v_pk_mul_f32 v[58:59], v[58:59], v[120:121]
  v_pk_mul_f32 v[60:61], v[60:61], v[120:121]
  v_pk_mul_f32 v[62:63], v[62:63], v[120:121]
  v_pk_mul_f32 v[64:65], v[64:65], v[120:121]
  v_pk_mul_f32 v[66:67], v[66:67], v[120:121]
  v_pk_mul_f32 v[68:69], v[68:69], v[120:121]
  v_pk_mul_f32 v[70:71], v[70:71], v[120:121]
  v_cvt_pk_bf16_f32 v196, v40, v41
  v_cvt_pk_bf16_f32 v197, v42, v43
  v_cvt_pk_bf16_f32 v198, v44, v45
  v_cvt_pk_bf16_f32 v199, v46, v47
  v_cvt_pk_bf16_f32 v200, v48, v49
  v_cvt_pk_bf16_f32 v201, v50, v51
  v_cvt_pk_bf16_f32 v202, v52, v53
  v_cvt_pk_bf16_f32 v203, v54, v55
  v_cvt_pk_bf16_f32 v204, v56, v57
  v_cvt_pk_bf16_f32 v205, v58, v59
  v_cvt_pk_bf16_f32 v206, v60, v61
  v_cvt_pk_bf16_f32 v207, v62, v63
  v_cvt_pk_bf16_f32 v208, v64, v65
  v_cvt_pk_bf16_f32 v209, v66, v67
  v_cvt_pk_bf16_f32 v210, v68, v69
  v_cvt_pk_bf16_f32 v211, v70, v71
  v_pk_mul_f32 v[72:73], v[72:73], v[124:125]
  v_pk_mul_f32 v[74:75], v[74:75], v[124:125]
  v_pk_mul_f32 v[76:77], v[76:77], v[124:125]
  v_pk_mul_f32 v[78:79], v[78:79], v[124:125]
  v_pk_mul_f32 v[80:81], v[80:81], v[124:125]
  v_pk_mul_f32 v[82:83], v[82:83], v[124:125]
  v_pk_mul_f32 v[84:85], v[84:85], v[124:125]
  v_pk_mul_f32 v[86:87], v[86:87], v[124:125]
  v_pk_mul_f32 v[88:89], v[88:89], v[124:125]
  v_pk_mul_f32 v[90:91], v[90:91], v[124:125]
  v_pk_mul_f32 v[92:93], v[92:93], v[124:125]
  v_pk_mul_f32 v[94:95], v[94:95], v[124:125]
  v_pk_mul_f32 v[96:97], v[96:97], v[124:125]
  v_pk_mul_f32 v[98:99], v[98:99], v[124:125]
  v_pk_mul_f32 v[100:101], v[100:101], v[124:125]
  v_pk_mul_f32 v[102:103], v[102:103], v[124:125]
  v_cvt_pk_bf16_f32 v212, v72, v73
  v_cvt_pk_bf16_f32 v213, v74, v75
  v_cvt_pk_bf16_f32 v214, v76, v77
  v_cvt_pk_bf16_f32 v215, v78, v79
  v_cvt_pk_bf16_f32 v216, v80, v81
  v_cvt_pk_bf16_f32 v217, v82, v83
  v_cvt_pk_bf16_f32 v218, v84, v85
  v_cvt_pk_bf16_f32 v219, v86, v87
  v_cvt_pk_bf16_f32 v220, v88, v89
  v_cvt_pk_bf16_f32 v221, v90, v91
  v_cvt_pk_bf16_f32 v222, v92, v93
  v_cvt_pk_bf16_f32 v223, v94, v95
  v_cvt_pk_bf16_f32 v224, v96, v97
  v_cvt_pk_bf16_f32 v225, v98, v99
  v_cvt_pk_bf16_f32 v226, v100, v101
  v_cvt_pk_bf16_f32 v227, v102, v103
  s_cmp_eq_u32 s44, 0
  s_cbranch_scc1 L_ep_l
  s_mul_i32 s52, s43, 393216
  s_add_u32 s52, s52, 4096
  buffer_store_dwordx4 v[180:183], v248, s[36:39], s52 offen offset:0 sc1
  buffer_store_dwordx4 v[184:187], v248, s[36:39], s52 offen offset:1024 sc1
  buffer_store_dwordx4 v[188:191], v248, s[36:39], s52 offen offset:2048 sc1
  buffer_store_dwordx4 v[192:195], v248, s[36:39], s52 offen offset:3072 sc1
  s_add_u32 s52, s52, 131072
  buffer_store_dwordx4 v[196:199], v248, s[36:39], s52 offen offset:0 sc1
  buffer_store_dwordx4 v[200:203], v248, s[36:39], s52 offen offset:1024 sc1
  buffer_store_dwordx4 v[204:207], v248, s[36:39], s52 offen offset:2048 sc1
  buffer_store_dwordx4 v[208:211], v248, s[36:39], s52 offen offset:3072 sc1
  s_add_u32 s52, s52, 131072
  buffer_store_dwordx4 v[212:215], v248, s[36:39], s52 offen offset:0 sc1
  buffer_store_dwordx4 v[216:219], v248, s[36:39], s52 offen offset:1024 sc1
  buffer_store_dwordx4 v[220:223], v248, s[36:39], s52 offen offset:2048 sc1
  buffer_store_dwordx4 v[224:227], v248, s[36:39], s52 offen offset:3072 sc1
  v_min_u32 v246, 2, v0
  v_lshlrev_b32 v246, 2, v246
  v_add_u32 v246, 163612, v246
L_ring:
  ds_read_b32 v244, v246 offset:0
  s_waitcnt lgkmcnt(0)
  v_cmp_gt_u32 vcc, 64, v244
  s_cbranch_vccz L_ring_ok
  s_add_u32 s99, s99, 1
  s_cmp_gt_u32 s99, 0x40000
  s_cbranch_scc1 L_end
  s_sleep 1
  s_branch L_ring
L_ring_ok:
  s_mul_i32 s52, s43, 3072
  v_add_u32 v244, s52, v248
  ds_write_b128 v244, v[180:183] offset:0
  ds_write_b128 v244, v[184:187] offset:18432
  ds_write_b128 v244, v[188:191] offset:36864
  ds_write_b128 v244, v[192:195] offset:55296
  ds_write_b128 v244, v[196:199] offset:1024
  ds_write_b128 v244, v[200:203] offset:19456
  ds_write_b128 v244, v[204:207] offset:37888
  ds_write_b128 v244, v[208:211] offset:56320
  ds_write_b128 v244, v[212:215] offset:2048
  ds_write_b128 v244, v[216:219] offset:20480
  ds_write_b128 v244, v[220:223] offset:38912
  ds_write_b128 v244, v[224:227] offset:57344
  s_waitcnt lgkmcnt(0)
  s_mov_b32 s95, 1
  s_branch L_prole2
L_ep_l:
  v_mov_b32 v245, 163664
L_wqx:
  ds_read_b32 v244, v245 offset:0
  s_waitcnt lgkmcnt(0)
  v_cmp_le_u32 vcc, 2, v244
  s_cbranch_vccnz L_wqx_ok
  s_add_u32 s99, s99, 1
  s_cmp_gt_u32 s99, 0x40000
  s_cbranch_scc1 L_end
  s_sleep 2
  s_branch L_wqx
L_wqx_ok:
  s_mul_i32 s52, s43, 3072
  s_add_u32 s52, s52, 73728
  v_add_u32 v244, s52, v248
  ds_write_b128 v244, v[180:183] offset:0
  ds_write_b128 v244, v[184:187] offset:18432
  ds_write_b128 v244, v[188:191] offset:36864
  ds_write_b128 v244, v[192:195] offset:55296
  ds_write_b128 v244, v[196:199] offset:1024
  ds_write_b128 v244, v[200:203] offset:19456
  ds_write_b128 v244, v[204:207] offset:37888
  ds_write_b128 v244, v[208:211] offset:56320
  ds_write_b128 v244, v[212:215] offset:2048
  ds_write_b128 v244, v[216:219] offset:20480
  ds_write_b128 v244, v[220:223] offset:38912
  ds_write_b128 v244, v[224:227] offset:57344
  s_waitcnt lgkmcnt(0)
  v_mov_b32 v245, 163668
  v_mov_b32 v246, 1
  s_mov_b64 exec, 1
  ds_add_u32 v245, v246
  s_mov_b64 exec, -1
  s_waitcnt lgkmcnt(0)
  s_cmp_eq_u32 s43, 1
  s_cbranch_scc1 L_x1
  s_setprio 0
  v_mov_b32 v245, 163668
L_woa:
  ds_read_b32 v244, v245 offset:0
  s_waitcnt lgkmcnt(0)
  v_cmp_le_u32 vcc, 3, v244
  s_cbranch_vccnz L_woa_ok
  s_add_u32 s99, s99, 1
  s_cmp_gt_u32 s99, 0x40000
  s_cbranch_scc1 L_end
  s_sleep 2
  s_branch L_woa
L_woa_ok:
  s_lshl_b32 s54, s43, 10
  s_mul_i32 s52, s43, 18432
  s_add_u32 s52, s52, 73728
  v_add_u32 v247, s52, v248
  ds_read_b128 v[8:11], v247 offset:0
  ds_read_b128 v[12:15], v247 offset:18432
  ds_read_b128 v[16:19], v247 offset:1024
  ds_read_b128 v[20:23], v247 offset:19456
  ds_read_b128 v[24:27], v247 offset:2048
  ds_read_b128 v[28:31], v247 offset:20480
  ds_read_b128 v[32:35], v247 offset:3072
  ds_read_b128 v[36:39], v247 offset:21504
  ds_read_b128 v[40:43], v247 offset:4096
  ds_read_b128 v[44:47], v247 offset:22528
  ds_read_b128 v[48:51], v247 offset:5120
  ds_read_b128 v[52:55], v247 offset:23552
  ds_read_b128 v[56:59], v247 offset:6144
  ds_read_b128 v[60:63], v247 offset:24576
  ds_read_b128 v[64:67], v247 offset:7168
  ds_read_b128 v[68:71], v247 offset:25600
  ds_read_b128 v[72:75], v247 offset:8192
  ds_read_b128 v[76:79], v247 offset:26624
  s_waitcnt lgkmcnt(0)
  v_mov_b32 v245, 163584
L_wcp:
  ds_read_b32 v244, v245 offset:0
  s_waitcnt lgkmcnt(0)
  v_cmp_le_u32 vcc, 63, v244
  s_cbranch_vccnz L_wcp_ok
  s_add_u32 s99, s99, 1
  s_cmp_gt_u32 s99, 0x40000
  s_cbranch_scc1 L_end
  s_sleep 4
  s_branch L_wcp
L_wcp_ok:
  s_add_u32 s52, s54, 0
  buffer_store_dwordx4 v[8:11], v248, s[36:39], s52 offen offset:0 sc1
  buffer_store_dwordx4 v[12:15], v248, s[36:39], s52 offen offset:1024 sc1
  s_add_u32 s52, s54, 131072
  buffer_store_dwordx4 v[16:19], v248, s[36:39], s52 offen offset:0 sc1
  buffer_store_dwordx4 v[20:23], v248, s[36:39], s52 offen offset:1024 sc1
  s_add_u32 s52, s54, 262144
  buffer_store_dwordx4 v[24:27], v248, s[36:39], s52 offen offset:0 sc1
  buffer_store_dwordx4 v[28:31], v248, s[36:39], s52 offen offset:1024 sc1
  s_add_u32 s52, s54, 393216
  buffer_store_dwordx4 v[32:35], v248, s[36:39], s52 offen offset:0 sc1
  buffer_store_dwordx4 v[36:39], v248, s[36:39], s52 offen offset:1024 sc1
  s_add_u32 s52, s54, 524288
  buffer_store_dwordx4 v[40:43], v248, s[36:39], s52 offen offset:0 sc1
  buffer_store_dwordx4 v[44:47], v248, s[36:39], s52 offen offset:1024 sc1
  s_add_u32 s52, s54, 655360
  buffer_store_dwordx4 v[48:51], v248, s[36:39], s52 offen offset:0 sc1
  buffer_store_dwordx4 v[52:55], v248, s[36:39], s52 offen offset:1024 sc1
  s_add_u32 s52, s54, 786432
  buffer_store_dwordx4 v[56:59], v248, s[36:39], s52 offen offset:0 sc1
  buffer_store_dwordx4 v[60:63], v248, s[36:39], s52 offen offset:1024 sc1
  s_add_u32 s52, s54, 917504
  buffer_store_dwordx4 v[64:67], v248, s[36:39], s52 offen offset:0 sc1
  buffer_store_dwordx4 v[68:71], v248, s[36:39], s52 offen offset:1024 sc1
  s_add_u32 s52, s54, 1048576
  buffer_store_dwordx4 v[72:75], v248, s[36:39], s52 offen offset:0 sc1
  buffer_store_dwordx4 v[76:79], v248, s[36:39], s52 offen offset:1024 sc1
  s_waitcnt vmcnt(0)
  v_mov_b32 v245, 163756
  v_mov_b32 v246, 1
  s_mov_b64 exec, 1
  ds_add_u32 v245, v246
  s_mov_b64 exec, -1
  s_waitcnt lgkmcnt(0)
  s_cmp_lg_u32 s43, 2
  s_cbranch_scc1 L_prole
  v_mov_b32 v245, 163756
L_woc:
  ds_read_b32 v244, v245 offset:0
  s_waitcnt lgkmcnt(0)
  v_cmp_le_u32 vcc, 2, v244
  s_cbranch_vccnz L_woc_ok
  s_add_u32 s99, s99, 1
  s_cmp_gt_u32 s99, 0x40000
  s_cbranch_scc1 L_end
  s_sleep 2
  s_branch L_woc
L_woc_ok:
  v_mov_b32 v245, 163680
L_wtag0:
  ds_read_b32 v244, v245 offset:0
  s_waitcnt lgkmcnt(0)
  v_cmp_le_u32 vcc, 1, v244
  s_cbranch_vccnz L_wtag0_ok
  s_add_u32 s99, s99, 1
  s_cmp_gt_u32 s99, 0x40000
  s_cbranch_scc1 L_end
  s_sleep 2
  s_branch L_wtag0
L_wtag0_ok:
  s_lshl_b32 s52, s55, 5
  s_add_u32 s52, s52, s56
  s_lshl_b32 s52, s52, 2
  v_mov_b32 v246, 0
  s_mov_b64 exec, 1
  buffer_store_dword v244, v246, s[68:71], s52 offen sc1
  s_mov_b64 exec, -1
  s_branch L_prole
L_yswitch:
  s_setprio 1
  v_mov_b64 v[8:9], 0
  v_mov_b64 v[10:11], 0
  v_mov_b64 v[12:13], 0
  v_mov_b64 v[14:15], 0
  v_mov_b64 v[16:17], 0
  v_mov_b64 v[18:19], 0
  v_mov_b64 v[20:21], 0
  v_mov_b64 v[22:23], 0
  v_mov_b64 v[24:25], 0
  v_mov_b64 v[26:27], 0
  v_mov_b64 v[28:29], 0
  v_mov_b64 v[30:31], 0
  v_mov_b64 v[32:33], 0
  v_mov_b64 v[34:35], 0
  v_mov_b64 v[36:37], 0
  v_mov_b64 v[38:39], 0
  v_mov_b64 v[40:41], 0
  v_mov_b64 v[42:43], 0
  v_mov_b64 v[44:45], 0
  v_mov_b64 v[46:47], 0
  v_mov_b64 v[48:49], 0
  v_mov_b64 v[50:51], 0
  v_mov_b64 v[52:53], 0
  v_mov_b64 v[54:55], 0
  v_mov_b64 v[56:57], 0
  v_mov_b64 v[58:59], 0
  v_mov_b64 v[60:61], 0
  v_mov_b64 v[62:63], 0
  v_mov_b64 v[64:65], 0
  v_mov_b64 v[66:67], 0
  v_mov_b64 v[68:69], 0
  v_mov_b64 v[70:71], 0
  v_mov_b64 v[72:73], 0
  v_mov_b64 v[74:75], 0
  v_mov_b64 v[76:77], 0
  v_mov_b64 v[78:79], 0
  v_mov_b64 v[80:81], 0
  v_mov_b64 v[82:83], 0
  v_mov_b64 v[84:85], 0
  v_mov_b64 v[86:87], 0
  v_mov_b64 v[88:89], 0
  v_mov_b64 v[90:91], 0
  v_mov_b64 v[92:93], 0
  v_mov_b64 v[94:95], 0
  v_mov_b64 v[96:97], 0
  v_mov_b64 v[98:99], 0
  v_mov_b64 v[100:101], 0
  v_mov_b64 v[102:103], 0
  v_mov_b64 v[104:105], 0
  v_mov_b64 v[106:107], 0
  v_mov_b64 v[108:109], 0
  v_mov_b64 v[110:111], 0
  v_mov_b64 v[112:113], 0
  v_mov_b64 v[114:115], 0
  v_mov_b64 v[116:117], 0
  v_mov_b64 v[118:119], 0
  v_mov_b64 v[120:121], 0
  v_mov_b64 v[122:123], 0
  v_mov_b64 v[124:125], 0
  v_mov_b64 v[126:127], 0
  s_mov_b32 s48, 0xff800000
  s_mov_b32 s51, 0xff800000
  s_mov_b32 s49, 0xff800000
  s_mov_b32 s66, 0xff800000
  s_mov_b32 s50, 0xff800000
  s_mov_b32 s67, 0xff800000
  s_mov_b32 s45, 32
  s_mov_b32 s46, 64
  v_mov_b32 v254, 32
  s_lshl_b32 s52, s43, 2
  s_add_u32 s52, s52, 163612
  v_lshlrev_b32 v255, 2, v0
  v_add_u32 v255, 163328, v255
    v_writelane_b32 v255, s52, 0
  s_nop 0
  v_mov_b32 v213, 163664
L_wqb:
  ds_read_b32 v212, v213 offset:0
  s_waitcnt lgkmcnt(0)
  v_cmp_le_u32 vcc, 2, v212
  s_cbranch_vccnz L_wqb_ok
  s_add_u32 s99, s99, 1
  s_cmp_gt_u32 s99, 0x40000
  s_cbranch_scc1 L_end
  s_sleep 6
  s_branch L_wqb
L_wqb_ok:
  s_mul_i32 s52, s43, 3072
  s_add_u32 s52, s52, 82944
  v_lshl_add_u32 v212, v0, 4, s52
  ds_read_b128 v[132:135], v212 offset:0
  ds_read_b128 v[136:139], v212 offset:18432
  ds_read_b128 v[140:143], v212 offset:36864
  ds_read_b128 v[144:147], v212 offset:55296
  ds_read_b128 v[148:151], v212 offset:1024
  ds_read_b128 v[152:155], v212 offset:19456
  ds_read_b128 v[156:159], v212 offset:37888
  ds_read_b128 v[160:163], v212 offset:56320
  ds_read_b128 v[164:167], v212 offset:2048
  ds_read_b128 v[168:171], v212 offset:20480
  ds_read_b128 v[172:175], v212 offset:38912
  ds_read_b128 v[176:179], v212 offset:57344
  s_waitcnt lgkmcnt(0)
  v_mov_b32 v213, 163584
L_wl31:
  ds_read_b32 v212, v213 offset:0
  s_waitcnt lgkmcnt(0)
  v_cmp_le_u32 vcc, 31, v212
  s_cbranch_vccnz L_wl31_ok
  s_add_u32 s99, s99, 1
  s_cmp_gt_u32 s99, 0x40000
  s_cbranch_scc1 L_end
  s_sleep 6
  s_branch L_wl31
L_wl31_ok:
  v_mov_b32 v5, 33
  s_waitcnt vmcnt(16)
  ds_max_u32 v2, v5
  s_branch L_astart
L_x1:
  s_mov_b32 s45, 33
  s_mov_b32 s57, 34
  s_mov_b32 s46, 62
  s_mov_b32 s58, 1
  s_mov_b32 s59, 18
  s_mov_b32 s62, 18
  s_mov_b32 s63, 18
  s_mov_b32 s92, 18
  s_branch L_linit
L_lrole:
  s_mov_b32 s45, 0
  s_mov_b32 s57, 0
  s_mov_b32 s46, 32
  s_mov_b32 s58, 0
  s_lshl_b32 s94, s98, 7
  s_lshl_b32 s93, s98, 19
  s_lshl_b32 s96, s98, 1
  s_mov_b32 s59, 0
  s_mov_b32 s62, 0
  s_mov_b32 s63, 0
  s_mov_b32 s92, 0
L_linit:
  s_mov_b32 s60, 0
  s_mov_b32 s61, 0
  s_mov_b32 s97, 0
  s_setprio 3
L_lit:
  s_add_u32 s52, s60, s61
  s_cmp_eq_u32 s52, 2
  s_cbranch_scc1 L_lw2
  s_cmp_eq_u32 s52, 1
  s_cbranch_scc1 L_lw1
  s_waitcnt vmcnt(16)
L_lw1:
  s_waitcnt vmcnt(33)
L_lw2:
  s_waitcnt vmcnt(50)
  s_cmp_lt_u32 s45, s57
  s_cbranch_scc1 L_lp_np
  s_cmp_eq_u32 s58, 0
  s_cbranch_scc1 L_lp_go
  v_mov_b32 v144, 163584
L_lp_prev:
  ds_read_b32 v143, v144 offset:0
  s_waitcnt lgkmcnt(0)
  v_cmp_le_u32 vcc, s45, v143
  s_cbranch_vccnz L_lp_prev_ok
  s_add_u32 s99, s99, 1
  s_cmp_gt_u32 s99, 0x40000
  s_cbranch_scc1 L_end
  s_sleep 2
  s_branch L_lp_prev
L_lp_prev_ok:
  s_mov_b32 s58, 0
L_lp_go:
  s_add_u32 s52, s45, 1
  v_mov_b32 v142, s52
  ds_max_u32 v145, v142
L_lp_np:
  v_mov_b32 v147, s92
  ds_write_b32 v146, v147 offset:0
  s_mov_b32 s62, s92
  s_add_i32 s52, s45, -1
  v_med3_i32 v141, s52, v139, v140
L_lc:
  ds_read_b32 v143, v138 offset:0
  s_waitcnt lgkmcnt(0)
  v_cmp_gt_u32 vcc, v141, v143
  s_cbranch_vccz L_lc_ok
  s_add_u32 s99, s99, 1
  s_cmp_gt_u32 s99, 0x40000
  s_cbranch_scc1 L_end
  s_sleep 1
  s_branch L_lc
L_lc_ok:
  s_add_u32 s52, s45, 2
  s_and_b32 s53, s52, 3
  s_lshl_b32 s53, s53, 14
  s_lshl_b32 s52, s52, 13
  s_add_u32 s54, s52, 4096
  s_add_u32 m0, s53, 0
  s_nop 0
  buffer_load_dwordx4 v132, s[28:31], s52 offen offset:0 nt lds
  buffer_load_dwordx4 v133, s[28:31], s52 offen offset:1024 nt lds
  buffer_load_dwordx4 v134, s[28:31], s52 offen offset:2048 nt lds
  buffer_load_dwordx4 v135, s[28:31], s52 offen offset:3072 nt lds
  s_add_u32 m0, s53, 4096
  s_nop 0
  buffer_load_dwordx4 v132, s[28:31], s54 offen offset:0 nt lds
  buffer_load_dwordx4 v133, s[28:31], s54 offen offset:1024 nt lds
  buffer_load_dwordx4 v134, s[28:31], s54 offen offset:2048 nt lds
  buffer_load_dwordx4 v135, s[28:31], s54 offen offset:3072 nt lds
  s_cmp_lg_u32 s60, 0
  s_cbranch_scc1 L_capb
  s_cmp_lg_u32 s61, 0
  s_cbranch_scc1 L_capc
  s_cmp_ge_u32 s45, 44
  s_cbranch_scc1 L_capd
  s_waitcnt vmcnt(9)
L_capd:
  s_waitcnt vmcnt(16)
  s_branch L_cap
L_capc:
  s_waitcnt vmcnt(13)
L_capb:
  s_waitcnt vmcnt(30)
L_cap:
  s_add_u32 m0, s53, 8192
  s_nop 0
  buffer_load_dwordx4 v136, s[32:35], s52 offen offset:0 nt lds
  buffer_load_dwordx4 v137, s[32:35], s52 offen offset:1024 nt lds
  buffer_load_dwordx4 v136, s[32:35], s52 offen offset:2048 nt lds
  buffer_load_dwordx4 v137, s[32:35], s52 offen offset:3072 nt lds
  s_add_u32 m0, s53, 12288
  s_nop 0
  buffer_load_dwordx4 v136, s[32:35], s54 offen offset:0 nt lds
  buffer_load_dwordx4 v137, s[32:35], s54 offen offset:1024 nt lds
  buffer_load_dwordx4 v136, s[32:35], s54 offen offset:2048 nt lds
  buffer_load_dwordx4 v137, s[32:35], s54 offen offset:3072 nt lds
  s_mov_b32 s92, s63
  s_mov_b32 s63, s59
  s_mov_b32 s61, s60
  s_mov_b32 s60, 0
  s_cmp_ge_u32 s59, 18
  s_cbranch_scc1 L_lq
  s_cmp_eq_u32 s59, 0
  s_cbranch_scc1 L_lq2
  s_cmp_lt_u32 s45, 2
  s_cbranch_scc1 L_lq
  s_add_u32 s97, s97, 1
  s_cmp_eq_u32 s97, 3
  s_cselect_b32 s97, 0, s97
  s_cbranch_scc1 L_lq
L_lq2:
  s_sub_i32 s52, s59, 3
  v_cmp_gt_i32 vcc, s52, v143
  s_nop 1
    s_and_b32 s52, vcc_lo, 0xc0
  s_cmp_eq_u32 s52, 0
  s_cbranch_scc0 L_lq
  s_and_b32 s53, s59, 3
  s_mul_i32 s53, s53, 17408
  s_add_u32 m0, s53, 74752
  s_nop 0
  buffer_load_dwordx4 v148, s[24:27], s93 offen offset:0 lds
  buffer_load_dwordx4 v149, s[24:27], s93 offen offset:1024 lds
  buffer_load_dwordx4 v150, s[24:27], s93 offen offset:2048 lds
  buffer_load_dwordx4 v151, s[24:27], s93 offen offset:3072 lds
  s_add_u32 m0, s53, 78848
  s_nop 0
  buffer_load_dwordx4 v152, s[24:27], s93 offen offset:0 lds
  buffer_load_dwordx4 v153, s[24:27], s93 offen offset:1024 lds
  buffer_load_dwordx4 v154, s[24:27], s93 offen offset:2048 lds
  buffer_load_dwordx4 v155, s[24:27], s93 offen offset:3072 lds
  s_add_u32 m0, s53, 65536
  s_nop 0
  buffer_load_dwordx4 v156, s[20:23], s94 offen offset:0 lds
  buffer_load_dwordx4 v157, s[20:23], s94 offen offset:1024 lds
  buffer_load_dwordx4 v158, s[20:23], s94 offen offset:2048 lds
  buffer_load_dwordx4 v159, s[20:23], s94 offen offset:3072 lds
  s_add_u32 m0, s53, 69632
  s_nop 0
  buffer_load_dwordx4 v160, s[20:23], s94 offen offset:0 lds
  buffer_load_dwordx4 v161, s[20:23], s94 offen offset:1024 lds
  buffer_load_dwordx4 v162, s[20:23], s94 offen offset:2048 lds
  buffer_load_dwordx4 v163, s[20:23], s94 offen offset:3072 lds
  s_add_u32 m0, s53, 73728
  s_nop 0
  buffer_load_dwordx4 v164, s[20:23], s94 offen offset:0 lds
  s_add_u32 s96, s96, 1
  s_cmp_eq_u32 s96, 18
  s_cselect_b32 s96, 0, s96
  s_cselect_b32 s52, 4294966208, 64
  s_add_u32 s94, s94, s52
  s_lshl_b32 s52, s52, 12
  s_add_u32 s93, s93, s52
  s_add_u32 s59, s59, 1
  s_mov_b32 s60, 1
L_lq:
  s_add_u32 s45, s45, 1
  s_cmp_lt_u32 s45, s46
  s_cbranch_scc1 L_lit
  s_cmp_lg_u32 s44, 0
  s_cbranch_scc1 L_lside
  s_waitcnt vmcnt(16)
  s_cmp_lt_u32 s45, s57
  s_cbranch_scc1 L_lt0_np
  s_cmp_eq_u32 s58, 0
  s_cbranch_scc1 L_lt0_go
  v_mov_b32 v144, 163584
L_lt0_prev:
  ds_read_b32 v143, v144 offset:0
  s_waitcnt lgkmcnt(0)
  v_cmp_le_u32 vcc, s45, v143
  s_cbranch_vccnz L_lt0_prev_ok
  s_add_u32 s99, s99, 1
  s_cmp_gt_u32 s99, 0x40000
  s_cbranch_scc1 L_end
  s_sleep 2
  s_branch L_lt0_prev
L_lt0_prev_ok:
  s_mov_b32 s58, 0
L_lt0_go:
  s_add_u32 s52, s45, 1
  v_mov_b32 v142, s52
  ds_max_u32 v145, v142
L_lt0_np:
  s_add_u32 s45, s45, 1
  s_waitcnt vmcnt(0)
  s_cmp_lt_u32 s45, s57
  s_cbranch_scc1 L_lt1_np
  s_cmp_eq_u32 s58, 0
  s_cbranch_scc1 L_lt1_go
  v_mov_b32 v144, 163584
L_lt1_prev:
  ds_read_b32 v143, v144 offset:0
  s_waitcnt lgkmcnt(0)
  v_cmp_le_u32 vcc, s45, v143
  s_cbranch_vccnz L_lt1_prev_ok
  s_add_u32 s99, s99, 1
  s_cmp_gt_u32 s99, 0x40000
  s_cbranch_scc1 L_end
  s_sleep 2
  s_branch L_lt1_prev
L_lt1_prev_ok:
  s_mov_b32 s58, 0
L_lt1_go:
  s_add_u32 s52, s45, 1
  v_mov_b32 v142, s52
  ds_max_u32 v145, v142
L_lt1_np:
  s_branch L_prole
L_lside:
  s_cmp_eq_u32 s62, 18
  s_cbranch_scc1 L_lqd
L_lqf:
  s_waitcnt vmcnt(0)
  v_mov_b32 v147, s59
  ds_write_b32 v146, v147 offset:0
  s_cmp_ge_u32 s59, 18
  s_cbranch_scc1 L_lqd
  s_add_u32 s99, s99, 1
  s_cmp_gt_u32 s99, 0x40000
  s_cbranch_scc1 L_end
  ds_read_b32 v143, v138 offset:0
  s_waitcnt lgkmcnt(0)
  s_sub_i32 s52, s59, 3
  v_cmp_gt_i32 vcc, s52, v143
  s_nop 1
    s_and_b32 s52, vcc_lo, 0xc0
  s_cmp_eq_u32 s52, 0
  s_cbranch_scc0 L_lqf
  s_and_b32 s53, s59, 3
  s_mul_i32 s53, s53, 17408
  s_add_u32 m0, s53, 74752
  s_nop 0
  buffer_load_dwordx4 v148, s[24:27], s93 offen offset:0 lds
  buffer_load_dwordx4 v149, s[24:27], s93 offen offset:1024 lds
  buffer_load_dwordx4 v150, s[24:27], s93 offen offset:2048 lds
  buffer_load_dwordx4 v151, s[24:27], s93 offen offset:3072 lds
  s_add_u32 m0, s53, 78848
  s_nop 0
  buffer_load_dwordx4 v152, s[24:27], s93 offen offset:0 lds
  buffer_load_dwordx4 v153, s[24:27], s93 offen offset:1024 lds
  buffer_load_dwordx4 v154, s[24:27], s93 offen offset:2048 lds
  buffer_load_dwordx4 v155, s[24:27], s93 offen offset:3072 lds
  s_add_u32 m0, s53, 65536
  s_nop 0
  buffer_load_dwordx4 v156, s[20:23], s94 offen offset:0 lds
  buffer_load_dwordx4 v157, s[20:23], s94 offen offset:1024 lds
  buffer_load_dwordx4 v158, s[20:23], s94 offen offset:2048 lds
  buffer_load_dwordx4 v159, s[20:23], s94 offen offset:3072 lds
  s_add_u32 m0, s53, 69632
  s_nop 0
  buffer_load_dwordx4 v160, s[20:23], s94 offen offset:0 lds
  buffer_load_dwordx4 v161, s[20:23], s94 offen offset:1024 lds
  buffer_load_dwordx4 v162, s[20:23], s94 offen offset:2048 lds
  buffer_load_dwordx4 v163, s[20:23], s94 offen offset:3072 lds
  s_add_u32 m0, s53, 73728
  s_nop 0
  buffer_load_dwordx4 v164, s[20:23], s94 offen offset:0 lds
  s_add_u32 s96, s96, 1
  s_cmp_eq_u32 s96, 18
  s_cselect_b32 s96, 0, s96
  s_cselect_b32 s52, 4294966208, 64
  s_add_u32 s94, s94, s52
  s_lshl_b32 s52, s52, 12
  s_add_u32 s93, s93, s52
  s_add_u32 s59, s59, 1
  s_branch L_lqf
L_lqd:
  v_lshlrev_b32 v2, 2, v0
  v_add_u32 v2, 163328, v2
  s_mov_b32 s53, 163584
    v_writelane_b32 v2, s53, 0
  s_nop 0
  s_branch L_yswitch
L_qb:
  s_setprio 1
  v_lshrrev_b32 v244, 3, v2
  v_lshlrev_b32 v244, 1, v244
  v_xor_b32 v244, v244, v3
  v_lshlrev_b32 v244, 4, v244
  v_lshl_add_u32 v244, v2, 6, v244
  v_add_u32 v216, 65536, v244
  v_lshrrev_b32 v244, 2, v2
  v_lshl_add_u32 v245, v3, 3, v244
  v_lshlrev_b32 v245, 8, v245
  v_and_b32 v246, 3, v0
  v_lshl_add_u32 v245, v246, 3, v245
  v_add_u32 v245, 74752, v245
  v_and_b32 v246, 1, v3
  v_lshl_add_u32 v244, v246, 2, v244
  s_lshl_b32 s52, s44, 2
  v_xor_b32 v244, s52, v244
  v_xor_b32 v246, 0, v244
  v_lshl_add_u32 v217, v246, 5, v245
  v_xor_b32 v246, 1, v244
  v_lshl_add_u32 v218, v246, 5, v245
  v_xor_b32 v246, 2, v244
  v_lshl_add_u32 v219, v246, 5, v245
  v_xor_b32 v246, 3, v244
  v_lshl_add_u32 v220, v246, 5, v245
  s_add_u32 s52, s52, 163624
  v_lshlrev_b32 v221, 2, v0
  v_add_u32 v221, 163328, v221
    v_writelane_b32 v221, s52, 0
  s_nop 0
  v_mov_b32 v240, 163728
  v_mov_b32 v222, 0
  v_mov_b32 v223, 1
  v_mov_b64 v[8:9], 0
  v_mov_b64 v[10:11], 0
  v_mov_b64 v[12:13], 0
  v_mov_b64 v[14:15], 0
  v_mov_b64 v[16:17], 0
  v_mov_b64 v[18:19], 0
  v_mov_b64 v[20:21], 0
  v_mov_b64 v[22:23], 0
  v_mov_b64 v[24:25], 0
  v_mov_b64 v[26:27], 0
  v_mov_b64 v[28:29], 0
  v_mov_b64 v[30:31], 0
  v_mov_b64 v[32:33], 0
  v_mov_b64 v[34:35], 0
  v_mov_b64 v[36:37], 0
  v_mov_b64 v[38:39], 0
  v_mov_b64 v[40:41], 0
  v_mov_b64 v[42:43], 0
  v_mov_b64 v[44:45], 0
  v_mov_b64 v[46:47], 0
  v_mov_b64 v[48:49], 0
  v_mov_b64 v[50:51], 0
  v_mov_b64 v[52:53], 0
  v_mov_b64 v[54:55], 0
  v_mov_b64 v[56:57], 0
  v_mov_b64 v[58:59], 0
  v_mov_b64 v[60:61], 0
  v_mov_b64 v[62:63], 0
  v_mov_b64 v[64:65], 0
  v_mov_b64 v[66:67], 0
  v_mov_b64 v[68:69], 0
  v_mov_b64 v[70:71], 0
  v_mov_b64 v[72:73], 0
  v_mov_b64 v[74:75], 0
  v_mov_b64 v[76:77], 0
  v_mov_b64 v[78:79], 0
  v_mov_b64 v[80:81], 0
  v_mov_b64 v[82:83], 0
  v_mov_b64 v[84:85], 0
  v_mov_b64 v[86:87], 0
  v_mov_b64 v[88:89], 0
  v_mov_b64 v[90:91], 0
  v_mov_b64 v[92:93], 0
  v_mov_b64 v[94:95], 0
  v_mov_b64 v[96:97], 0
  v_mov_b64 v[98:99], 0
  v_mov_b64 v[100:101], 0
  v_mov_b64 v[102:103], 0
  v_mov_b64 v[104:105], 0
  v_mov_b64 v[106:107], 0
  v_mov_b64 v[108:109], 0
  v_mov_b64 v[110:111], 0
  v_mov_b64 v[112:113], 0
  v_mov_b64 v[114:115], 0
  v_mov_b64 v[116:117], 0
  v_mov_b64 v[118:119], 0
  v_mov_b64 v[120:121], 0
  v_mov_b64 v[122:123], 0
  v_mov_b64 v[124:125], 0
  v_mov_b64 v[126:127], 0
  v_mov_b64 v[128:129], 0
  v_mov_b64 v[130:131], 0
  v_mov_b64 v[132:133], 0
  v_mov_b64 v[134:135], 0
  v_mov_b64 v[136:137], 0
  v_mov_b64 v[138:139], 0
  v_mov_b64 v[140:141], 0
  v_mov_b64 v[142:143], 0
  v_mov_b64 v[144:145], 0
  v_mov_b64 v[146:147], 0
  v_mov_b64 v[148:149], 0
  v_mov_b64 v[150:151], 0
  s_mov_b32 s45, 0
  v_cmp_le_u32 vcc, v223, v222
  s_cbranch_vccnz L_qh1_ok
L_qh1:
  s_add_u32 s99, s99, 1
  s_cmp_gt_u32 s99, 0x40000
  s_cbranch_scc1 L_end
  s_sleep 2
  ds_read_b32 v222, v240 offset:0
  s_waitcnt lgkmcnt(0)
  v_cmp_le_u32 vcc, v223, v222
  s_cbranch_vccz L_qh1
L_qh1_ok:
  ds_read_b64_tr_b16 v[188:189], v217 offset:0
  ds_read_b64_tr_b16 v[190:191], v217 offset:1024
  ds_read_b64_tr_b16 v[192:193], v218 offset:0
  ds_read_b64_tr_b16 v[194:195], v218 offset:1024
  ds_read_b64_tr_b16 v[196:197], v219 offset:0
  ds_read_b64_tr_b16 v[198:199], v219 offset:1024
  ds_read_b64_tr_b16 v[200:201], v220 offset:0
  ds_read_b64_tr_b16 v[202:203], v220 offset:1024
  ds_read_b128 v[152:155], v216 offset:0
  ds_read_b128 v[156:159], v216 offset:1024
  ds_read_b128 v[160:163], v216 offset:2048
  ds_read_b128 v[164:167], v216 offset:3072
  ds_read_b128 v[168:171], v216 offset:4096
  ds_read_b128 v[172:175], v216 offset:5120
  ds_read_b128 v[176:179], v216 offset:6144
  ds_read_b128 v[180:183], v216 offset:7168
  ds_read_b128 v[184:187], v216 offset:8192
L_qbloop:
  s_waitcnt lgkmcnt(0)
  ds_write_b32 v221, v223 offset:0
  v_add_u32 v223, 1, v223
  v_min_u32 v223, 18, v223
  v_cmp_le_u32 vcc, v223, v222
  s_cbranch_vccnz L_qh2_ok
L_qh2:
  s_add_u32 s99, s99, 1
  s_cmp_gt_u32 s99, 0x40000
  s_cbranch_scc1 L_end
  s_sleep 2
  ds_read_b32 v222, v240 offset:0
  s_waitcnt lgkmcnt(0)
  v_cmp_le_u32 vcc, v223, v222
  s_cbranch_vccz L_qh2
L_qh2_ok:
  v_mfma_f32_16x16x32_bf16 v[8:11], v[188:191], v[152:155], v[8:11]
  v_mfma_f32_16x16x32_bf16 v[12:15], v[192:195], v[152:155], v[12:15]
  ds_read_b64_tr_b16 v[224:225], v217 offset:17408
  v_mfma_f32_16x16x32_bf16 v[16:19], v[196:199], v[152:155], v[16:19]
  v_mfma_f32_16x16x32_bf16 v[20:23], v[200:203], v[152:155], v[20:23]
  ds_read_b128 v[152:155], v216 offset:17408
  v_mfma_f32_16x16x32_bf16 v[24:27], v[188:191], v[156:159], v[24:27]
  v_mfma_f32_16x16x32_bf16 v[28:31], v[192:195], v[156:159], v[28:31]
  ds_read_b64_tr_b16 v[226:227], v217 offset:18432
  v_mfma_f32_16x16x32_bf16 v[32:35], v[196:199], v[156:159], v[32:35]
  v_mfma_f32_16x16x32_bf16 v[36:39], v[200:203], v[156:159], v[36:39]
  ds_read_b128 v[156:159], v216 offset:18432
  v_mfma_f32_16x16x32_bf16 v[40:43], v[188:191], v[160:163], v[40:43]
  v_mfma_f32_16x16x32_bf16 v[44:47], v[192:195], v[160:163], v[44:47]
  ds_read_b64_tr_b16 v[228:229], v218 offset:17408
  v_mfma_f32_16x16x32_bf16 v[48:51], v[196:199], v[160:163], v[48:51]
  v_mfma_f32_16x16x32_bf16 v[52:55], v[200:203], v[160:163], v[52:55]
  ds_read_b128 v[160:163], v216 offset:19456
  v_mfma_f32_16x16x32_bf16 v[56:59], v[188:191], v[164:167], v[56:59]
  v_mfma_f32_16x16x32_bf16 v[60:63], v[192:195], v[164:167], v[60:63]
  ds_read_b64_tr_b16 v[230:231], v218 offset:18432
  v_mfma_f32_16x16x32_bf16 v[64:67], v[196:199], v[164:167], v[64:67]
  v_mfma_f32_16x16x32_bf16 v[68:71], v[200:203], v[164:167], v[68:71]
  ds_read_b128 v[164:167], v216 offset:20480
  v_mfma_f32_16x16x32_bf16 v[72:75], v[188:191], v[168:171], v[72:75]
  v_mfma_f32_16x16x32_bf16 v[76:79], v[192:195], v[168:171], v[76:79]
  ds_read_b64_tr_b16 v[232:233], v219 offset:17408
  v_mfma_f32_16x16x32_bf16 v[80:83], v[196:199], v[168:171], v[80:83]
  v_mfma_f32_16x16x32_bf16 v[84:87], v[200:203], v[168:171], v[84:87]
  ds_read_b128 v[168:171], v216 offset:21504
  v_mfma_f32_16x16x32_bf16 v[88:91], v[188:191], v[172:175], v[88:91]
  v_mfma_f32_16x16x32_bf16 v[92:95], v[192:195], v[172:175], v[92:95]
  ds_read_b64_tr_b16 v[234:235], v219 offset:18432
  v_mfma_f32_16x16x32_bf16 v[96:99], v[196:199], v[172:175], v[96:99]
  v_mfma_f32_16x16x32_bf16 v[100:103], v[200:203], v[172:175], v[100:103]
  ds_read_b128 v[172:175], v216 offset:22528
  v_mfma_f32_16x16x32_bf16 v[104:107], v[188:191], v[176:179], v[104:107]
  v_mfma_f32_16x16x32_bf16 v[108:111], v[192:195], v[176:179], v[108:111]
  ds_read_b64_tr_b16 v[236:237], v220 offset:17408
  v_mfma_f32_16x16x32_bf16 v[112:115], v[196:199], v[176:179], v[112:115]
  v_mfma_f32_16x16x32_bf16 v[116:119], v[200:203], v[176:179], v[116:119]
  ds_read_b128 v[176:179], v216 offset:23552
  v_mfma_f32_16x16x32_bf16 v[120:123], v[188:191], v[180:183], v[120:123]
  v_mfma_f32_16x16x32_bf16 v[124:127], v[192:195], v[180:183], v[124:127]
  ds_read_b64_tr_b16 v[238:239], v220 offset:18432
  v_mfma_f32_16x16x32_bf16 v[128:131], v[196:199], v[180:183], v[128:131]
  s_add_u32 s45, s45, 1
  v_mfma_f32_16x16x32_bf16 v[132:135], v[200:203], v[180:183], v[132:135]
  ds_read_b128 v[180:183], v216 offset:24576
  s_cmp_eq_u32 s45, 18
  v_mfma_f32_16x16x32_bf16 v[136:139], v[188:191], v[184:187], v[136:139]
  v_mfma_f32_16x16x32_bf16 v[140:143], v[192:195], v[184:187], v[140:143]
  ds_read_b32 v222, v240 offset:0
  v_mfma_f32_16x16x32_bf16 v[144:147], v[196:199], v[184:187], v[144:147]
  v_mfma_f32_16x16x32_bf16 v[148:151], v[200:203], v[184:187], v[148:151]
  ds_read_b128 v[184:187], v216 offset:25600
  s_waitcnt lgkmcnt(0)
  ds_write_b32 v221, v223 offset:0
  v_add_u32 v223, 1, v223
  v_min_u32 v223, 18, v223
  v_cmp_le_u32 vcc, v223, v222
  s_cbranch_vccnz L_qh3_ok
L_qh3:
  s_add_u32 s99, s99, 1
  s_cmp_gt_u32 s99, 0x40000
  s_cbranch_scc1 L_end
  s_sleep 2
  ds_read_b32 v222, v240 offset:0
  s_waitcnt lgkmcnt(0)
  v_cmp_le_u32 vcc, v223, v222
  s_cbranch_vccz L_qh3
L_qh3_ok:
  v_mfma_f32_16x16x32_bf16 v[8:11], v[224:227], v[152:155], v[8:11]
  v_mfma_f32_16x16x32_bf16 v[12:15], v[228:231], v[152:155], v[12:15]
  ds_read_b64_tr_b16 v[188:189], v217 offset:34816
  v_mfma_f32_16x16x32_bf16 v[16:19], v[232:235], v[152:155], v[16:19]
  v_mfma_f32_16x16x32_bf16 v[20:23], v[236:239], v[152:155], v[20:23]
  ds_read_b128 v[152:155], v216 offset:34816
  v_mfma_f32_16x16x32_bf16 v[24:27], v[224:227], v[156:159], v[24:27]
  v_mfma_f32_16x16x32_bf16 v[28:31], v[228:231], v[156:159], v[28:31]
  ds_read_b64_tr_b16 v[190:191], v217 offset:35840
  v_mfma_f32_16x16x32_bf16 v[32:35], v[232:235], v[156:159], v[32:35]
  v_mfma_f32_16x16x32_bf16 v[36:39], v[236:239], v[156:159], v[36:39]
  ds_read_b128 v[156:159], v216 offset:35840
  v_mfma_f32_16x16x32_bf16 v[40:43], v[224:227], v[160:163], v[40:43]
  v_mfma_f32_16x16x32_bf16 v[44:47], v[228:231], v[160:163], v[44:47]
  ds_read_b64_tr_b16 v[192:193], v218 offset:34816
  v_mfma_f32_16x16x32_bf16 v[48:51], v[232:235], v[160:163], v[48:51]
  v_mfma_f32_16x16x32_bf16 v[52:55], v[236:239], v[160:163], v[52:55]
  ds_read_b128 v[160:163], v216 offset:36864
  v_mfma_f32_16x16x32_bf16 v[56:59], v[224:227], v[164:167], v[56:59]
  v_mfma_f32_16x16x32_bf16 v[60:63], v[228:231], v[164:167], v[60:63]
  ds_read_b64_tr_b16 v[194:195], v218 offset:35840
  v_mfma_f32_16x16x32_bf16 v[64:67], v[232:235], v[164:167], v[64:67]
  v_mfma_f32_16x16x32_bf16 v[68:71], v[236:239], v[164:167], v[68:71]
  ds_read_b128 v[164:167], v216 offset:37888
  v_mfma_f32_16x16x32_bf16 v[72:75], v[224:227], v[168:171], v[72:75]
  v_mfma_f32_16x16x32_bf16 v[76:79], v[228:231], v[168:171], v[76:79]
  ds_read_b64_tr_b16 v[196:197], v219 offset:34816
  v_mfma_f32_16x16x32_bf16 v[80:83], v[232:235], v[168:171], v[80:83]
  v_mfma_f32_16x16x32_bf16 v[84:87], v[236:239], v[168:171], v[84:87]
  ds_read_b128 v[168:171], v216 offset:38912
  v_mfma_f32_16x16x32_bf16 v[88:91], v[224:227], v[172:175], v[88:91]
  v_mfma_f32_16x16x32_bf16 v[92:95], v[228:231], v[172:175], v[92:95]
  ds_read_b64_tr_b16 v[198:199], v219 offset:35840
  v_mfma_f32_16x16x32_bf16 v[96:99], v[232:235], v[172:175], v[96:99]
  v_mfma_f32_16x16x32_bf16 v[100:103], v[236:239], v[172:175], v[100:103]
  ds_read_b128 v[172:175], v216 offset:39936
  v_mfma_f32_16x16x32_bf16 v[104:107], v[224:227], v[176:179], v[104:107]
  v_mfma_f32_16x16x32_bf16 v[108:111], v[228:231], v[176:179], v[108:111]
  ds_read_b64_tr_b16 v[200:201], v220 offset:34816
  v_mfma_f32_16x16x32_bf16 v[112:115], v[232:235], v[176:179], v[112:115]
  v_mfma_f32_16x16x32_bf16 v[116:119], v[236:239], v[176:179], v[116:119]
  ds_read_b128 v[176:179], v216 offset:40960
  v_mfma_f32_16x16x32_bf16 v[120:123], v[224:227], v[180:183], v[120:123]
  v_mfma_f32_16x16x32_bf16 v[124:127], v[228:231], v[180:183], v[124:127]
  ds_read_b64_tr_b16 v[202:203], v220 offset:35840
  v_mfma_f32_16x16x32_bf16 v[128:131], v[232:235], v[180:183], v[128:131]
  s_add_u32 s45, s45, 1
  v_mfma_f32_16x16x32_bf16 v[132:135], v[236:239], v[180:183], v[132:135]
  ds_read_b128 v[180:183], v216 offset:41984
  s_cmp_eq_u32 s45, 18
  v_mfma_f32_16x16x32_bf16 v[136:139], v[224:227], v[184:187], v[136:139]
  v_mfma_f32_16x16x32_bf16 v[140:143], v[228:231], v[184:187], v[140:143]
  ds_read_b32 v222, v240 offset:0
  v_mfma_f32_16x16x32_bf16 v[144:147], v[232:235], v[184:187], v[144:147]
  v_mfma_f32_16x16x32_bf16 v[148:151], v[236:239], v[184:187], v[148:151]
  ds_read_b128 v[184:187], v216 offset:43008
  s_cbranch_scc1 L_qbend
  s_waitcnt lgkmcnt(0)
  ds_write_b32 v221, v223 offset:0
  v_add_u32 v223, 1, v223
  v_min_u32 v223, 18, v223
  v_cmp_le_u32 vcc, v223, v222
  s_cbranch_vccnz L_qh4_ok
L_qh4:
  s_add_u32 s99, s99, 1
  s_cmp_gt_u32 s99, 0x40000
  s_cbranch_scc1 L_end
  s_sleep 2
  ds_read_b32 v222, v240 offset:0
  s_waitcnt lgkmcnt(0)
  v_cmp_le_u32 vcc, v223, v222
  s_cbranch_vccz L_qh4
L_qh4_ok:
  v_mfma_f32_16x16x32_bf16 v[8:11], v[188:191], v[152:155], v[8:11]
  v_mfma_f32_16x16x32_bf16 v[12:15], v[192:195], v[152:155], v[12:15]
  ds_read_b64_tr_b16 v[224:225], v217 offset:52224
  v_mfma_f32_16x16x32_bf16 v[16:19], v[196:199], v[152:155], v[16:19]
  v_mfma_f32_16x16x32_bf16 v[20:23], v[200:203], v[152:155], v[20:23]
  ds_read_b128 v[152:155], v216 offset:52224
  v_mfma_f32_16x16x32_bf16 v[24:27], v[188:191], v[156:159], v[24:27]
  v_mfma_f32_16x16x32_bf16 v[28:31], v[192:195], v[156:159], v[28:31]
  ds_read_b64_tr_b16 v[226:227], v217 offset:53248
  v_mfma_f32_16x16x32_bf16 v[32:35], v[196:199], v[156:159], v[32:35]
  v_mfma_f32_16x16x32_bf16 v[36:39], v[200:203], v[156:159], v[36:39]
  ds_read_b128 v[156:159], v216 offset:53248
  v_mfma_f32_16x16x32_bf16 v[40:43], v[188:191], v[160:163], v[40:43]
  v_mfma_f32_16x16x32_bf16 v[44:47], v[192:195], v[160:163], v[44:47]
  ds_read_b64_tr_b16 v[228:229], v218 offset:52224
  v_mfma_f32_16x16x32_bf16 v[48:51], v[196:199], v[160:163], v[48:51]
  v_mfma_f32_16x16x32_bf16 v[52:55], v[200:203], v[160:163], v[52:55]
  ds_read_b128 v[160:163], v216 offset:54272
  v_mfma_f32_16x16x32_bf16 v[56:59], v[188:191], v[164:167], v[56:59]
  v_mfma_f32_16x16x32_bf16 v[60:63], v[192:195], v[164:167], v[60:63]
  ds_read_b64_tr_b16 v[230:231], v218 offset:53248
  v_mfma_f32_16x16x32_bf16 v[64:67], v[196:199], v[164:167], v[64:67]
  v_mfma_f32_16x16x32_bf16 v[68:71], v[200:203], v[164:167], v[68:71]
  ds_read_b128 v[164:167], v216 offset:55296
  v_mfma_f32_16x16x32_bf16 v[72:75], v[188:191], v[168:171], v[72:75]
  v_mfma_f32_16x16x32_bf16 v[76:79], v[192:195], v[168:171], v[76:79]
  ds_read_b64_tr_b16 v[232:233], v219 offset:52224
  v_mfma_f32_16x16x32_bf16 v[80:83], v[196:199], v[168:171], v[80:83]
  v_mfma_f32_16x16x32_bf16 v[84:87], v[200:203], v[168:171], v[84:87]
  ds_read_b128 v[168:171], v216 offset:56320
  v_mfma_f32_16x16x32_bf16 v[88:91], v[188:191], v[172:175], v[88:91]
  v_mfma_f32_16x16x32_bf16 v[92:95], v[192:195], v[172:175], v[92:95]
  ds_read_b64_tr_b16 v[234:235], v219 offset:53248
  v_mfma_f32_16x16x32_bf16 v[96:99], v[196:199], v[172:175], v[96:99]
  v_mfma_f32_16x16x32_bf16 v[100:103], v[200:203], v[172:175], v[100:103]
  ds_read_b128 v[172:175], v216 offset:57344
  v_mfma_f32_16x16x32_bf16 v[104:107], v[188:191], v[176:179], v[104:107]
  v_mfma_f32_16x16x32_bf16 v[108:111], v[192:195], v[176:179], v[108:111]
  ds_read_b64_tr_b16 v[236:237], v220 offset:52224
  v_mfma_f32_16x16x32_bf16 v[112:115], v[196:199], v[176:179], v[112:115]
  v_mfma_f32_16x16x32_bf16 v[116:119], v[200:203], v[176:179], v[116:119]
  ds_read_b128 v[176:179], v216 offset:58368
  v_mfma_f32_16x16x32_bf16 v[120:123], v[188:191], v[180:183], v[120:123]
  v_mfma_f32_16x16x32_bf16 v[124:127], v[192:195], v[180:183], v[124:127]
  ds_read_b64_tr_b16 v[238:239], v220 offset:53248
  v_mfma_f32_16x16x32_bf16 v[128:131], v[196:199], v[180:183], v[128:131]
  s_add_u32 s45, s45, 1
  v_mfma_f32_16x16x32_bf16 v[132:135], v[200:203], v[180:183], v[132:135]
  ds_read_b128 v[180:183], v216 offset:59392
  s_cmp_eq_u32 s45, 18
  v_mfma_f32_16x16x32_bf16 v[136:139], v[188:191], v[184:187], v[136:139]
  v_mfma_f32_16x16x32_bf16 v[140:143], v[192:195], v[184:187], v[140:143]
  ds_read_b32 v222, v240 offset:0
  v_mfma_f32_16x16x32_bf16 v[144:147], v[196:199], v[184:187], v[144:147]
  v_mfma_f32_16x16x32_bf16 v[148:151], v[200:203], v[184:187], v[148:151]
  ds_read_b128 v[184:187], v216 offset:60416
  s_waitcnt lgkmcnt(0)
  ds_write_b32 v221, v223 offset:0
  v_add_u32 v223, 1, v223
  v_min_u32 v223, 18, v223
  v_cmp_le_u32 vcc, v223, v222
  s_cbranch_vccnz L_qh5_ok
L_qh5:
  s_add_u32 s99, s99, 1
  s_cmp_gt_u32 s99, 0x40000
  s_cbranch_scc1 L_end
  s_sleep 2
  ds_read_b32 v222, v240 offset:0
  s_waitcnt lgkmcnt(0)
  v_cmp_le_u32 vcc, v223, v222
  s_cbranch_vccz L_qh5
L_qh5_ok:
  v_mfma_f32_16x16x32_bf16 v[8:11], v[224:227], v[152:155], v[8:11]
  v_mfma_f32_16x16x32_bf16 v[12:15], v[228:231], v[152:155], v[12:15]
  ds_read_b64_tr_b16 v[188:189], v217 offset:0
  v_mfma_f32_16x16x32_bf16 v[16:19], v[232:235], v[152:155], v[16:19]
  v_mfma_f32_16x16x32_bf16 v[20:23], v[236:239], v[152:155], v[20:23]
  ds_read_b128 v[152:155], v216 offset:0
  v_mfma_f32_16x16x32_bf16 v[24:27], v[224:227], v[156:159], v[24:27]
  v_mfma_f32_16x16x32_bf16 v[28:31], v[228:231], v[156:159], v[28:31]
  ds_read_b64_tr_b16 v[190:191], v217 offset:1024
  v_mfma_f32_16x16x32_bf16 v[32:35], v[232:235], v[156:159], v[32:35]
  v_mfma_f32_16x16x32_bf16 v[36:39], v[236:239], v[156:159], v[36:39]
  ds_read_b128 v[156:159], v216 offset:1024
  v_mfma_f32_16x16x32_bf16 v[40:43], v[224:227], v[160:163], v[40:43]
  v_mfma_f32_16x16x32_bf16 v[44:47], v[228:231], v[160:163], v[44:47]
  ds_read_b64_tr_b16 v[192:193], v218 offset:0
  v_mfma_f32_16x16x32_bf16 v[48:51], v[232:235], v[160:163], v[48:51]
  v_mfma_f32_16x16x32_bf16 v[52:55], v[236:239], v[160:163], v[52:55]
  ds_read_b128 v[160:163], v216 offset:2048
  v_mfma_f32_16x16x32_bf16 v[56:59], v[224:227], v[164:167], v[56:59]
  v_mfma_f32_16x16x32_bf16 v[60:63], v[228:231], v[164:167], v[60:63]
  ds_read_b64_tr_b16 v[194:195], v218 offset:1024
  v_mfma_f32_16x16x32_bf16 v[64:67], v[232:235], v[164:167], v[64:67]
  v_mfma_f32_16x16x32_bf16 v[68:71], v[236:239], v[164:167], v[68:71]
  ds_read_b128 v[164:167], v216 offset:3072
  v_mfma_f32_16x16x32_bf16 v[72:75], v[224:227], v[168:171], v[72:75]
  v_mfma_f32_16x16x32_bf16 v[76:79], v[228:231], v[168:171], v[76:79]
  ds_read_b64_tr_b16 v[196:197], v219 offset:0
  v_mfma_f32_16x16x32_bf16 v[80:83], v[232:235], v[168:171], v[80:83]
  v_mfma_f32_16x16x32_bf16 v[84:87], v[236:239], v[168:171], v[84:87]
  ds_read_b128 v[168:171], v216 offset:4096
  v_mfma_f32_16x16x32_bf16 v[88:91], v[224:227], v[172:175], v[88:91]
  v_mfma_f32_16x16x32_bf16 v[92:95], v[228:231], v[172:175], v[92:95]
  ds_read_b64_tr_b16 v[198:199], v219 offset:1024
  v_mfma_f32_16x16x32_bf16 v[96:99], v[232:235], v[172:175], v[96:99]
  v_mfma_f32_16x16x32_bf16 v[100:103], v[236:239], v[172:175], v[100:103]
  ds_read_b128 v[172:175], v216 offset:5120
  v_mfma_f32_16x16x32_bf16 v[104:107], v[224:227], v[176:179], v[104:107]
  v_mfma_f32_16x16x32_bf16 v[108:111], v[228:231], v[176:179], v[108:111]
  ds_read_b64_tr_b16 v[200:201], v220 offset:0
  v_mfma_f32_16x16x32_bf16 v[112:115], v[232:235], v[176:179], v[112:115]
  v_mfma_f32_16x16x32_bf16 v[116:119], v[236:239], v[176:179], v[116:119]
  ds_read_b128 v[176:179], v216 offset:6144
  v_mfma_f32_16x16x32_bf16 v[120:123], v[224:227], v[180:183], v[120:123]
  v_mfma_f32_16x16x32_bf16 v[124:127], v[228:231], v[180:183], v[124:127]
  ds_read_b64_tr_b16 v[202:203], v220 offset:1024
  v_mfma_f32_16x16x32_bf16 v[128:131], v[232:235], v[180:183], v[128:131]
  s_add_u32 s45, s45, 1
  v_mfma_f32_16x16x32_bf16 v[132:135], v[236:239], v[180:183], v[132:135]
  ds_read_b128 v[180:183], v216 offset:7168
  s_cmp_eq_u32 s45, 18
  v_mfma_f32_16x16x32_bf16 v[136:139], v[224:227], v[184:187], v[136:139]
  v_mfma_f32_16x16x32_bf16 v[140:143], v[228:231], v[184:187], v[140:143]
  ds_read_b32 v222, v240 offset:0
  v_mfma_f32_16x16x32_bf16 v[144:147], v[232:235], v[184:187], v[144:147]
  v_mfma_f32_16x16x32_bf16 v[148:151], v[236:239], v[184:187], v[148:151]
  ds_read_b128 v[184:187], v216 offset:8192
  s_branch L_qbloop
L_qbend:
  s_waitcnt lgkmcnt(0)
  v_mov_b32 v223, 19
  ds_write_b32 v221, v223 offset:0
  v_pk_mul_f32 v[8:9], v[8:9], s[64:65]
  v_pk_mul_f32 v[10:11], v[10:11], s[64:65]
  v_pk_mul_f32 v[12:13], v[12:13], s[64:65]
  v_pk_mul_f32 v[14:15], v[14:15], s[64:65]
  v_pk_mul_f32 v[16:17], v[16:17], s[64:65]
  v_pk_mul_f32 v[18:19], v[18:19], s[64:65]
  v_pk_mul_f32 v[20:21], v[20:21], s[64:65]
  v_pk_mul_f32 v[22:23], v[22:23], s[64:65]
  v_pk_mul_f32 v[24:25], v[24:25], s[64:65]
  v_pk_mul_f32 v[26:27], v[26:27], s[64:65]
  v_pk_mul_f32 v[28:29], v[28:29], s[64:65]
  v_pk_mul_f32 v[30:31], v[30:31], s[64:65]
  v_pk_mul_f32 v[32:33], v[32:33], s[64:65]
  v_pk_mul_f32 v[34:35], v[34:35], s[64:65]
  v_pk_mul_f32 v[36:37], v[36:37], s[64:65]
  v_pk_mul_f32 v[38:39], v[38:39], s[64:65]
  v_pk_mul_f32 v[40:41], v[40:41], s[64:65]
  v_pk_mul_f32 v[42:43], v[42:43], s[64:65]
  v_pk_mul_f32 v[44:45], v[44:45], s[64:65]
  v_pk_mul_f32 v[46:47], v[46:47], s[64:65]
  v_pk_mul_f32 v[48:49], v[48:49], s[64:65]
  v_pk_mul_f32 v[50:51], v[50:51], s[64:65]
  v_pk_mul_f32 v[52:53], v[52:53], s[64:65]
  v_pk_mul_f32 v[54:55], v[54:55], s[64:65]
  v_pk_mul_f32 v[56:57], v[56:57], s[64:65]
  v_pk_mul_f32 v[58:59], v[58:59], s[64:65]
  v_pk_mul_f32 v[60:61], v[60:61], s[64:65]
  v_pk_mul_f32 v[62:63], v[62:63], s[64:65]
  v_pk_mul_f32 v[64:65], v[64:65], s[64:65]
  v_pk_mul_f32 v[66:67], v[66:67], s[64:65]
  v_pk_mul_f32 v[68:69], v[68:69], s[64:65]
  v_pk_mul_f32 v[70:71], v[70:71], s[64:65]
  v_pk_mul_f32 v[72:73], v[72:73], s[64:65]
  v_pk_mul_f32 v[74:75], v[74:75], s[64:65]
  v_pk_mul_f32 v[76:77], v[76:77], s[64:65]
  v_pk_mul_f32 v[78:79], v[78:79], s[64:65]
  v_pk_mul_f32 v[80:81], v[80:81], s[64:65]
  v_pk_mul_f32 v[82:83], v[82:83], s[64:65]
  v_pk_mul_f32 v[84:85], v[84:85], s[64:65]
  v_pk_mul_f32 v[86:87], v[86:87], s[64:65]
  v_pk_mul_f32 v[88:89], v[88:89], s[64:65]
  v_pk_mul_f32 v[90:91], v[90:91], s[64:65]
  v_pk_mul_f32 v[92:93], v[92:93], s[64:65]
  v_pk_mul_f32 v[94:95], v[94:95], s[64:65]
  v_pk_mul_f32 v[96:97], v[96:97], s[64:65]
  v_pk_mul_f32 v[98:99], v[98:99], s[64:65]
  v_pk_mul_f32 v[100:101], v[100:101], s[64:65]
  v_pk_mul_f32 v[102:103], v[102:103], s[64:65]
  v_pk_mul_f32 v[104:105], v[104:105], s[64:65]
  v_pk_mul_f32 v[106:107], v[106:107], s[64:65]
  v_pk_mul_f32 v[108:109], v[108:109], s[64:65]
  v_pk_mul_f32 v[110:111], v[110:111], s[64:65]
  v_pk_mul_f32 v[112:113], v[112:113], s[64:65]
  v_pk_mul_f32 v[114:115], v[114:115], s[64:65]
  v_pk_mul_f32 v[116:117], v[116:117], s[64:65]
  v_pk_mul_f32 v[118:119], v[118:119], s[64:65]
  v_pk_mul_f32 v[120:121], v[120:121], s[64:65]
  v_pk_mul_f32 v[122:123], v[122:123], s[64:65]
  v_pk_mul_f32 v[124:125], v[124:125], s[64:65]
  v_pk_mul_f32 v[126:127], v[126:127], s[64:65]
  v_pk_mul_f32 v[128:129], v[128:129], s[64:65]
  v_pk_mul_f32 v[130:131], v[130:131], s[64:65]
  v_pk_mul_f32 v[132:133], v[132:133], s[64:65]
  v_pk_mul_f32 v[134:135], v[134:135], s[64:65]
  v_pk_mul_f32 v[136:137], v[136:137], s[64:65]
  v_pk_mul_f32 v[138:139], v[138:139], s[64:65]
  v_pk_mul_f32 v[140:141], v[140:141], s[64:65]
  v_pk_mul_f32 v[142:143], v[142:143], s[64:65]
  v_pk_mul_f32 v[144:145], v[144:145], s[64:65]
  v_pk_mul_f32 v[146:147], v[146:147], s[64:65]
  v_pk_mul_f32 v[148:149], v[148:149], s[64:65]
  v_pk_mul_f32 v[150:151], v[150:151], s[64:65]
  v_cvt_pk_bf16_f32 v8, v8, v9
  v_cvt_pk_bf16_f32 v9, v10, v11
  v_cvt_pk_bf16_f32 v10, v12, v13
  v_cvt_pk_bf16_f32 v11, v14, v15
  v_cvt_pk_bf16_f32 v12, v16, v17
  v_cvt_pk_bf16_f32 v13, v18, v19
  v_cvt_pk_bf16_f32 v14, v20, v21
  v_cvt_pk_bf16_f32 v15, v22, v23
  v_cvt_pk_bf16_f32 v16, v24, v25
  v_cvt_pk_bf16_f32 v17, v26, v27
  v_cvt_pk_bf16_f32 v18, v28, v29
  v_cvt_pk_bf16_f32 v19, v30, v31
  v_cvt_pk_bf16_f32 v20, v32, v33
  v_cvt_pk_bf16_f32 v21, v34, v35
  v_cvt_pk_bf16_f32 v22, v36, v37
  v_cvt_pk_bf16_f32 v23, v38, v39
  v_cvt_pk_bf16_f32 v24, v40, v41
  v_cvt_pk_bf16_f32 v25, v42, v43
  v_cvt_pk_bf16_f32 v26, v44, v45
  v_cvt_pk_bf16_f32 v27, v46, v47
  v_cvt_pk_bf16_f32 v28, v48, v49
  v_cvt_pk_bf16_f32 v29, v50, v51
  v_cvt_pk_bf16_f32 v30, v52, v53
  v_cvt_pk_bf16_f32 v31, v54, v55
  v_cvt_pk_bf16_f32 v32, v56, v57
  v_cvt_pk_bf16_f32 v33, v58, v59
  v_cvt_pk_bf16_f32 v34, v60, v61
  v_cvt_pk_bf16_f32 v35, v62, v63
  v_cvt_pk_bf16_f32 v36, v64, v65
  v_cvt_pk_bf16_f32 v37, v66, v67
  v_cvt_pk_bf16_f32 v38, v68, v69
  v_cvt_pk_bf16_f32 v39, v70, v71
  v_cvt_pk_bf16_f32 v40, v72, v73
  v_cvt_pk_bf16_f32 v41, v74, v75
  v_cvt_pk_bf16_f32 v42, v76, v77
  v_cvt_pk_bf16_f32 v43, v78, v79
  v_cvt_pk_bf16_f32 v44, v80, v81
  v_cvt_pk_bf16_f32 v45, v82, v83
  v_cvt_pk_bf16_f32 v46, v84, v85
  v_cvt_pk_bf16_f32 v47, v86, v87
  v_cvt_pk_bf16_f32 v48, v88, v89
  v_cvt_pk_bf16_f32 v49, v90, v91
  v_cvt_pk_bf16_f32 v50, v92, v93
  v_cvt_pk_bf16_f32 v51, v94, v95
  v_cvt_pk_bf16_f32 v52, v96, v97
  v_cvt_pk_bf16_f32 v53, v98, v99
  v_cvt_pk_bf16_f32 v54, v100, v101
  v_cvt_pk_bf16_f32 v55, v102, v103
  v_cvt_pk_bf16_f32 v56, v104, v105
  v_cvt_pk_bf16_f32 v57, v106, v107
  v_cvt_pk_bf16_f32 v58, v108, v109
  v_cvt_pk_bf16_f32 v59, v110, v111
  v_cvt_pk_bf16_f32 v60, v112, v113
  v_cvt_pk_bf16_f32 v61, v114, v115
  v_cvt_pk_bf16_f32 v62, v116, v117
  v_cvt_pk_bf16_f32 v63, v118, v119
  v_cvt_pk_bf16_f32 v64, v120, v121
  v_cvt_pk_bf16_f32 v65, v122, v123
  v_cvt_pk_bf16_f32 v66, v124, v125
  v_cvt_pk_bf16_f32 v67, v126, v127
  v_cvt_pk_bf16_f32 v68, v128, v129
  v_cvt_pk_bf16_f32 v69, v130, v131
  v_cvt_pk_bf16_f32 v70, v132, v133
  v_cvt_pk_bf16_f32 v71, v134, v135
  v_cvt_pk_bf16_f32 v72, v136, v137
  v_cvt_pk_bf16_f32 v73, v138, v139
  v_cvt_pk_bf16_f32 v74, v140, v141
  v_cvt_pk_bf16_f32 v75, v142, v143
  v_cvt_pk_bf16_f32 v76, v144, v145
  v_cvt_pk_bf16_f32 v77, v146, v147
  v_cvt_pk_bf16_f32 v78, v148, v149
  v_cvt_pk_bf16_f32 v79, v150, v151
  s_lshl_b32 s52, s44, 2
  s_xor_b32 s52, s52, 4
  s_add_u32 s52, s52, 163624
  v_mov_b32 v240, s52
  v_mov_b32 v222, 0
  v_cmp_le_u32 vcc, v223, v222
  s_cbranch_vccnz L_qh6_ok
L_qh6:
  s_add_u32 s99, s99, 1
  s_cmp_gt_u32 s99, 0x40000
  s_cbranch_scc1 L_end
  s_sleep 2
  ds_read_b32 v222, v240 offset:0
  s_waitcnt lgkmcnt(0)
  v_cmp_le_u32 vcc, v223, v222
  s_cbranch_vccz L_qh6
L_qh6_ok:
  s_mul_i32 s52, s44, 36864
  s_add_u32 s52, s52, 82944
  v_lshrrev_b32 v244, 1, v3
  v_lshl_add_u32 v244, v244, 4, v2
  v_lshlrev_b32 v244, 4, v244
  v_and_b32 v245, 1, v3
  v_lshl_add_u32 v244, v245, 3, v244
  v_add_u32 v244, s52, v244
  ds_write_b64 v244, v[8:9] offset:0
  ds_write_b64 v244, v[10:11] offset:512
  ds_write_b64 v244, v[12:13] offset:18432
  ds_write_b64 v244, v[14:15] offset:18944
  ds_write_b64 v244, v[16:17] offset:1024
  ds_write_b64 v244, v[18:19] offset:1536
  ds_write_b64 v244, v[20:21] offset:19456
  ds_write_b64 v244, v[22:23] offset:19968
  ds_write_b64 v244, v[24:25] offset:2048
  ds_write_b64 v244, v[26:27] offset:2560
  ds_write_b64 v244, v[28:29] offset:20480
  ds_write_b64 v244, v[30:31] offset:20992
  ds_write_b64 v244, v[32:33] offset:3072
  ds_write_b64 v244, v[34:35] offset:3584
  ds_write_b64 v244, v[36:37] offset:21504
  ds_write_b64 v244, v[38:39] offset:22016
  ds_write_b64 v244, v[40:41] offset:4096
  ds_write_b64 v244, v[42:43] offset:4608
  ds_write_b64 v244, v[44:45] offset:22528
  ds_write_b64 v244, v[46:47] offset:23040
  ds_write_b64 v244, v[48:49] offset:5120
  ds_write_b64 v244, v[50:51] offset:5632
  ds_write_b64 v244, v[52:53] offset:23552
  ds_write_b64 v244, v[54:55] offset:24064
  ds_write_b64 v244, v[56:57] offset:6144
  ds_write_b64 v244, v[58:59] offset:6656
  ds_write_b64 v244, v[60:61] offset:24576
  ds_write_b64 v244, v[62:63] offset:25088
  ds_write_b64 v244, v[64:65] offset:7168
  ds_write_b64 v244, v[66:67] offset:7680
  ds_write_b64 v244, v[68:69] offset:25600
  ds_write_b64 v244, v[70:71] offset:26112
  ds_write_b64 v244, v[72:73] offset:8192
  ds_write_b64 v244, v[74:75] offset:8704
  ds_write_b64 v244, v[76:77] offset:26624
  ds_write_b64 v244, v[78:79] offset:27136
  s_waitcnt lgkmcnt(0)
  v_mov_b32 v245, 163664
  v_mov_b32 v246, 1
  s_mov_b64 exec, 1
  ds_add_u32 v245, v246
  s_mov_b64 exec, -1
  s_waitcnt lgkmcnt(0)
  s_setprio 0
  s_branch L_prole
L_stuba0_0:
  s_call_b64 s[40:41], L_rare0
  s_branch L_backa0_0
L_stuba0_1:
  s_call_b64 s[40:41], L_rare1
  s_branch L_backa0_1
L_stuba0_2:
  s_call_b64 s[40:41], L_rare2
  s_branch L_backa0_2
L_stuba1_0:
  s_call_b64 s[40:41], L_rare0
  s_branch L_backa1_0
L_stuba1_1:
  s_call_b64 s[40:41], L_rare1
  s_branch L_backa1_1
L_stuba1_2:
  s_call_b64 s[40:41], L_rare2
  s_branch L_backa1_2
L_stuba2_0:
  s_call_b64 s[40:41], L_rare0
  s_branch L_backa2_0
L_stuba2_1:
  s_call_b64 s[40:41], L_rare1
  s_branch L_backa2_1
L_stuba2_2:
  s_call_b64 s[40:41], L_rare2
  s_branch L_backa2_2
L_stuba3_0:
  s_call_b64 s[40:41], L_rare0
  s_branch L_backa3_0
L_stuba3_1:
  s_call_b64 s[40:41], L_rare1
  s_branch L_backa3_1
L_stuba3_2:
  s_call_b64 s[40:41], L_rare2
  s_branch L_backa3_2
L_rare0:
  s_nop 7
  v_mov_b32 v250, v248
  s_nop 1
  v_permlane32_swap_b32 v248, v250
  v_max_f32 v248, v248, v250
  v_mov_b32 v250, v248
  s_nop 1
  v_permlane16_swap_b32 v248, v250
  v_max_f32 v248, v248, v250
  v_max_f32 v248, s51, v248
  v_max_f32 v251, 0, v248
  v_exp_f32 v251, -v251
  v_sub_f32 v116, v116, v248
  v_sub_f32 v117, v117, v248
  v_sub_f32 v118, v118, v248
  v_sub_f32 v119, v119, v248
  v_sub_f32 v212, v212, v248
  v_sub_f32 v213, v213, v248
  v_sub_f32 v214, v214, v248
  v_sub_f32 v215, v215, v248
  v_sub_f32 v216, v216, v248
  v_sub_f32 v217, v217, v248
  v_sub_f32 v218, v218, v248
  v_sub_f32 v219, v219, v248
  s_cmp_lg_u32 s51, 0
  s_cbranch_scc1 L_rarex0
  v_mul_f32 v8, v8, v251
  v_mul_f32 v9, v9, v251
  v_mul_f32 v10, v10, v251
  v_mul_f32 v11, v11, v251
  v_mul_f32 v12, v12, v251
  v_mul_f32 v13, v13, v251
  v_mul_f32 v14, v14, v251
  v_mul_f32 v15, v15, v251
  v_mul_f32 v16, v16, v251
  v_mul_f32 v17, v17, v251
  v_mul_f32 v18, v18, v251
  v_mul_f32 v19, v19, v251
  v_mul_f32 v20, v20, v251
  v_mul_f32 v21, v21, v251
  v_mul_f32 v22, v22, v251
  v_mul_f32 v23, v23, v251
  v_mul_f32 v24, v24, v251
  v_mul_f32 v25, v25, v251
  v_mul_f32 v26, v26, v251
  v_mul_f32 v27, v27, v251
  v_mul_f32 v28, v28, v251
  v_mul_f32 v29, v29, v251
  v_mul_f32 v30, v30, v251
  v_mul_f32 v31, v31, v251
  v_mul_f32 v32, v32, v251
  v_mul_f32 v33, v33, v251
  v_mul_f32 v34, v34, v251
  v_mul_f32 v35, v35, v251
  v_mul_f32 v36, v36, v251
  v_mul_f32 v37, v37, v251
  v_mul_f32 v38, v38, v251
  v_mul_f32 v39, v39, v251
  v_mul_f32 v104, v104, v251
  v_mul_f32 v105, v105, v251
  v_mul_f32 v106, v106, v251
  v_mul_f32 v107, v107, v251
L_rarex0:
  s_mov_b32 s48, 0x41000000
  s_mov_b32 s51, 0
  s_setpc_b64 s[40:41]
L_rare1:
  s_nop 7
  v_mov_b32 v250, v249
  s_nop 1
  v_permlane32_swap_b32 v249, v250
  v_max_f32 v249, v249, v250
  v_mov_b32 v250, v249
  s_nop 1
  v_permlane16_swap_b32 v249, v250
  v_max_f32 v249, v249, v250
  v_max_f32 v249, s66, v249
  v_max_f32 v251, 0, v249
  v_exp_f32 v251, -v251
  v_sub_f32 v120, v120, v249
  v_sub_f32 v121, v121, v249
  v_sub_f32 v122, v122, v249
  v_sub_f32 v123, v123, v249
  v_sub_f32 v220, v220, v249
  v_sub_f32 v221, v221, v249
  v_sub_f32 v222, v222, v249
  v_sub_f32 v223, v223, v249
  v_sub_f32 v224, v224, v249
  v_sub_f32 v225, v225, v249
  v_sub_f32 v226, v226, v249
  v_sub_f32 v227, v227, v249
  s_cmp_lg_u32 s66, 0
  s_cbranch_scc1 L_rarex1
  v_mul_f32 v40, v40, v251
  v_mul_f32 v41, v41, v251
  v_mul_f32 v42, v42, v251
  v_mul_f32 v43, v43, v251
  v_mul_f32 v44, v44, v251
  v_mul_f32 v45, v45, v251
  v_mul_f32 v46, v46, v251
  v_mul_f32 v47, v47, v251
  v_mul_f32 v48, v48, v251
  v_mul_f32 v49, v49, v251
  v_mul_f32 v50, v50, v251
  v_mul_f32 v51, v51, v251
  v_mul_f32 v52, v52, v251
  v_mul_f32 v53, v53, v251
  v_mul_f32 v54, v54, v251
  v_mul_f32 v55, v55, v251
  v_mul_f32 v56, v56, v251
  v_mul_f32 v57, v57, v251
  v_mul_f32 v58, v58, v251
  v_mul_f32 v59, v59, v251
  v_mul_f32 v60, v60, v251
  v_mul_f32 v61, v61, v251
  v_mul_f32 v62, v62, v251
  v_mul_f32 v63, v63, v251
  v_mul_f32 v64, v64, v251
  v_mul_f32 v65, v65, v251
  v_mul_f32 v66, v66, v251
  v_mul_f32 v67, v67, v251
  v_mul_f32 v68, v68, v251
  v_mul_f32 v69, v69, v251
  v_mul_f32 v70, v70, v251
  v_mul_f32 v71, v71, v251
  v_mul_f32 v108, v108, v251
  v_mul_f32 v109, v109, v251
  v_mul_f32 v110, v110, v251
  v_mul_f32 v111, v111, v251
L_rarex1:
  s_mov_b32 s49, 0x41000000
  s_mov_b32 s66, 0
  s_setpc_b64 s[40:41]
L_rare2:
  s_nop 7
  v_mov_b32 v250, v248
  s_nop 1
  v_permlane32_swap_b32 v248, v250
  v_max_f32 v248, v248, v250
  v_mov_b32 v250, v248
  s_nop 1
  v_permlane16_swap_b32 v248, v250
  v_max_f32 v248, v248, v250
  v_max_f32 v248, s67, v248
  v_max_f32 v251, 0, v248
  v_exp_f32 v251, -v251
  v_sub_f32 v124, v124, v248
  v_sub_f32 v125, v125, v248
  v_sub_f32 v126, v126, v248
  v_sub_f32 v127, v127, v248
  v_sub_f32 v228, v228, v248
  v_sub_f32 v229, v229, v248
  v_sub_f32 v230, v230, v248
  v_sub_f32 v231, v231, v248
  v_sub_f32 v232, v232, v248
  v_sub_f32 v233, v233, v248
  v_sub_f32 v234, v234, v248
  v_sub_f32 v235, v235, v248
  s_cmp_lg_u32 s67, 0
  s_cbranch_scc1 L_rarex2
  v_mul_f32 v72, v72, v251
  v_mul_f32 v73, v73, v251
  v_mul_f32 v74, v74, v251
  v_mul_f32 v75, v75, v251
  v_mul_f32 v76, v76, v251
  v_mul_f32 v77, v77, v251
  v_mul_f32 v78, v78, v251
  v_mul_f32 v79, v79, v251
  v_mul_f32 v80, v80, v251
  v_mul_f32 v81, v81, v251
  v_mul_f32 v82, v82, v251
  v_mul_f32 v83, v83, v251
  v_mul_f32 v84, v84, v251
  v_mul_f32 v85, v85, v251
  v_mul_f32 v86, v86, v251
  v_mul_f32 v87, v87, v251
  v_mul_f32 v88, v88, v251
  v_mul_f32 v89, v89, v251
  v_mul_f32 v90, v90, v251
  v_mul_f32 v91, v91, v251
  v_mul_f32 v92, v92, v251
  v_mul_f32 v93, v93, v251
  v_mul_f32 v94, v94, v251
  v_mul_f32 v95, v95, v251
  v_mul_f32 v96, v96, v251
  v_mul_f32 v97, v97, v251
  v_mul_f32 v98, v98, v251
  v_mul_f32 v99, v99, v251
  v_mul_f32 v100, v100, v251
  v_mul_f32 v101, v101, v251
  v_mul_f32 v102, v102, v251
  v_mul_f32 v103, v103, v251
  v_mul_f32 v112, v112, v251
  v_mul_f32 v113, v113, v251
  v_mul_f32 v114, v114, v251
  v_mul_f32 v115, v115, v251
L_rarex2:
  s_mov_b32 s50, 0x41000000
  s_mov_b32 s67, 0
  s_setpc_b64 s[40:41]
L_prole:
  s_mov_b32 s95, 0
L_prole2:
  s_cmp_lg_u32 s44, 0
  s_cbranch_scc1 L_t_y
  s_cmp_lt_u32 s42, 2
  s_cbranch_scc1 L_t_x01
L_t_y:
  s_mul_i32 s52, s55, 1179648
  s_lshl_b32 s53, s3, 15
  s_add_u32 s52, s52, s53
  s_sub_u32 s54, 1179648, s53
  s_add_u32 s76, s18, s52
  s_addc_u32 s77, s19, 0
  s_mov_b32 s78, s54
  s_mov_b32 s79, 0x20000
  s_mul_i32 s52, s3, 1179648
  s_mul_i32 s53, s47, 288
  s_add_u32 s52, s52, s53
  s_sub_u32 s54, 4718592, s52
  s_add_u32 s80, s12, s52
  s_addc_u32 s81, s13, 0
  s_mov_b32 s82, s54
  s_mov_b32 s83, 0x20000
  v_lshlrev_b32 v225, 4, v0
  v_mov_b32 v233, 163680
L_t_tag226:
  ds_read_b32 v232, v233 offset:0
  s_waitcnt lgkmcnt(0)
  v_cmp_le_u32 vcc, 1, v232
  s_cbranch_vccnz L_t_tag226_ok
  s_add_u32 s99, s99, 1
  s_cmp_gt_u32 s99, 0x40000
  s_cbranch_scc1 L_end
  s_sleep 2
  s_branch L_t_tag226
L_t_tag226_ok:
  v_readfirstlane_b32 s93, v232
  v_and_b32 v226, 7, v0
  v_lshlrev_b32 v226, 2, v226
  s_lshl_b32 s52, s55, 7
  s_lshl_b32 s53, s3, 5
  s_add_u32 s52, s52, s53
  v_add_u32 v226, s52, v226
  s_mov_b32 s62, 0
  v_mov_b32 v227, 0
  v_add_u32 v232, 0, v0
  v_mul_u32_u24 v233, 3641, v232
  v_lshrrev_b32 v233, 16, v233
  v_mul_u32_u24 v233, 864, v233
  v_lshl_add_u32 v216, v232, 4, v233
  v_add_u32 v232, 64, v0
  v_mul_u32_u24 v233, 3641, v232
  v_lshrrev_b32 v233, 16, v233
  v_mul_u32_u24 v233, 864, v233
  v_lshl_add_u32 v217, v232, 4, v233
  v_add_u32 v232, 128, v0
  v_mul_u32_u24 v233, 3641, v232
  v_lshrrev_b32 v233, 16, v233
  v_mul_u32_u24 v233, 864, v233
  v_lshl_add_u32 v218, v232, 4, v233
  v_add_u32 v232, 192, v0
  v_mul_u32_u24 v233, 3641, v232
  v_lshrrev_b32 v233, 16, v233
  v_mul_u32_u24 v233, 864, v233
  v_lshl_add_u32 v219, v232, 4, v233
  v_add_u32 v232, 256, v0
  v_mul_u32_u24 v233, 3641, v232
  v_lshrrev_b32 v233, 16, v233
  v_mul_u32_u24 v233, 864, v233
  v_lshl_add_u32 v220, v232, 4, v233
  v_add_u32 v232, 320, v0
  v_mul_u32_u24 v233, 3641, v232
  v_lshrrev_b32 v233, 16, v233
  v_mul_u32_u24 v233, 864, v233
  v_lshl_add_u32 v221, v232, 4, v233
  v_add_u32 v232, 384, v0
  v_mul_u32_u24 v233, 3641, v232
  v_lshrrev_b32 v233, 16, v233
  v_mul_u32_u24 v233, 864, v233
  v_lshl_add_u32 v222, v232, 4, v233
  v_add_u32 v232, 448, v0
  v_mul_u32_u24 v233, 3641, v232
  v_lshrrev_b32 v233, 16, v233
  v_mul_u32_u24 v233, 864, v233
  v_lshl_add_u32 v223, v232, 4, v233
  v_add_u32 v232, 512, v0
  v_mul_u32_u24 v233, 3641, v232
  v_lshrrev_b32 v233, 16, v233
  v_mul_u32_u24 v233, 864, v233
  v_lshl_add_u32 v224, v232, 4, v233
  s_cmp_lg_u32 s44, 0
  s_cbranch_scc1 L_t_y2
  s_cmp_eq_u32 s42, 2
  s_cbranch_scc1 L_t_x01
  v_mov_b32 v233, 163584
L_t_lpf:
  ds_read_b32 v232, v233 offset:0
  s_waitcnt lgkmcnt(0)
  v_cmp_le_u32 vcc, 33, v232
  s_cbranch_vccnz L_t_lpf_ok
  s_add_u32 s99, s99, 1
  s_cmp_gt_u32 s99, 0x40000
  s_cbranch_scc1 L_end
  s_sleep 6
  s_branch L_t_lpf
L_t_lpf_ok:
  v_mul_u32_u24 v235, 1152, v0
  s_and_b32 s52, s55, 7
  s_mul_i32 s60, s52, 147456
  buffer_load_dword v252, v235, s[80:83], s60 offen offset:0
  buffer_load_dword v252, v235, s[80:83], s60 offen offset:128
  buffer_load_dword v252, v235, s[80:83], s60 offen offset:284
  s_add_u32 s60, s60, 73728
  buffer_load_dword v252, v235, s[80:83], s60 offen offset:0
  buffer_load_dword v252, v235, s[80:83], s60 offen offset:128
  buffer_load_dword v252, v235, s[80:83], s60 offen offset:284
  s_add_u32 s60, s60, 73728
L_t_pre:
  v_mov_b32 v233, 163584
L_t_lpre:
  ds_read_b32 v232, v233 offset:0
  s_waitcnt lgkmcnt(0)
  v_cmp_le_u32 vcc, 63, v232
  s_cbranch_vccnz L_t_lpre_ok
  s_add_u32 s99, s99, 1
  s_cmp_gt_u32 s99, 0x40000
  s_cbranch_scc1 L_end
  s_sleep 4
  s_branch L_t_lpre
L_t_lpre_ok:
  s_mov_b32 s59, 0
L_t_prl:
L_t_prw:
  s_lshr_b32 s52, s59, 1
  s_lshl_b32 s52, s52, 2
  s_lshr_b32 s52, 0x75364210, s52
  s_lshl_b32 s53, s47, 1
  s_add_u32 s63, s52, s53
  s_and_b32 s63, s63, 7
  s_lshl_b32 s52, s59, 1
  s_add_u32 s52, s52, 0
  s_add_u32 s53, s52, 4
  s_and_b32 s53, s53, 7
  s_mul_i32 s61, s53, 18432
  s_and_b32 s52, s52, 3
  s_lshl_b32 s53, s63, 2
  s_add_u32 s52, s52, s53
  s_mul_i32 s60, s52, 36864
  s_add_u32 m0, s61, 9216
  s_nop 0
  buffer_load_dwordx4 v216, s[80:83], s60 offen lds
  s_add_u32 m0, s61, 10240
  s_nop 0
  buffer_load_dwordx4 v217, s[80:83], s60 offen lds
  s_add_u32 m0, s61, 11264
  s_nop 0
  buffer_load_dwordx4 v218, s[80:83], s60 offen lds
  s_add_u32 m0, s61, 12288
  s_nop 0
  buffer_load_dwordx4 v219, s[80:83], s60 offen lds
  s_add_u32 m0, s61, 13312
  s_nop 0
  buffer_load_dwordx4 v220, s[80:83], s60 offen lds
  s_add_u32 m0, s61, 14336
  s_nop 0
  buffer_load_dwordx4 v221, s[80:83], s60 offen lds
  s_add_u32 m0, s61, 15360
  s_nop 0
  buffer_load_dwordx4 v222, s[80:83], s60 offen lds
  s_add_u32 m0, s61, 16384
  s_nop 0
  buffer_load_dwordx4 v223, s[80:83], s60 offen lds
  s_add_u32 m0, s61, 17408
  s_nop 0
  buffer_load_dwordx4 v224, s[80:83], s60 offen lds
  s_lshr_b32 s52, s59, 1
  s_lshl_b32 s52, s52, 2
  s_lshr_b32 s52, 0x75364210, s52
  s_lshl_b32 s53, s47, 1
  s_add_u32 s63, s52, s53
  s_and_b32 s63, s63, 7
  s_lshl_b32 s52, s59, 1
  s_add_u32 s52, s52, 1
  s_add_u32 s53, s52, 4
  s_and_b32 s53, s53, 7
  s_mul_i32 s61, s53, 18432
  s_and_b32 s52, s52, 3
  s_lshl_b32 s53, s63, 2
  s_add_u32 s52, s52, s53
  s_mul_i32 s60, s52, 36864
  s_add_u32 m0, s61, 9216
  s_nop 0
  buffer_load_dwordx4 v216, s[80:83], s60 offen lds
  s_add_u32 m0, s61, 10240
  s_nop 0
  buffer_load_dwordx4 v217, s[80:83], s60 offen lds
  s_add_u32 m0, s61, 11264
  s_nop 0
  buffer_load_dwordx4 v218, s[80:83], s60 offen lds
  s_add_u32 m0, s61, 12288
  s_nop 0
  buffer_load_dwordx4 v219, s[80:83], s60 offen lds
  s_add_u32 m0, s61, 13312
  s_nop 0
  buffer_load_dwordx4 v220, s[80:83], s60 offen lds
  s_add_u32 m0, s61, 14336
  s_nop 0
  buffer_load_dwordx4 v221, s[80:83], s60 offen lds
  s_add_u32 m0, s61, 15360
  s_nop 0
  buffer_load_dwordx4 v222, s[80:83], s60 offen lds
  s_add_u32 m0, s61, 16384
  s_nop 0
  buffer_load_dwordx4 v223, s[80:83], s60 offen lds
  s_add_u32 m0, s61, 17408
  s_nop 0
  buffer_load_dwordx4 v224, s[80:83], s60 offen lds
L_t_prn:
  s_add_u32 s59, s59, 1
  s_cmp_lt_u32 s59, 2
  s_cbranch_scc1 L_t_prl
  s_branch L_t_x01
L_t_y2:
  s_lshr_b32 s88, s43, 1
  s_cmp_eq_u32 s95, 0
  s_cbranch_scc1 L_bpy
  s_waitcnt vmcnt(0)
  v_mov_b32 v245, 163672
  v_mov_b32 v246, 1
  s_mov_b64 exec, 1
  ds_add_rtn_u32 v247, v245, v246
  s_mov_b64 exec, -1
  s_waitcnt lgkmcnt(0)
  v_readfirstlane_b32 s52, v247
  s_nop 0
  s_cmp_lg_u32 s52, 2
  s_cbranch_scc1 L_bpy
  v_mov_b32 v245, 163680
L_wtag1y:
  ds_read_b32 v244, v245 offset:0
  s_waitcnt lgkmcnt(0)
  v_cmp_le_u32 vcc, 1, v244
  s_cbranch_vccnz L_wtag1y_ok
  s_add_u32 s99, s99, 1
  s_cmp_gt_u32 s99, 0x40000
  s_cbranch_scc1 L_end
  s_sleep 2
  s_branch L_wtag1y
L_wtag1y_ok:
  s_lshl_b32 s52, s55, 5
  s_add_u32 s52, s52, s56
  s_lshl_b32 s52, s52, 2
  v_mov_b32 v246, 4
  s_mov_b64 exec, 1
  buffer_store_dword v244, v246, s[68:71], s52 offen sc1
  s_mov_b64 exec, -1
L_bpy:
  s_barrier
  s_setprio 0
  s_bitcmp1_b32 s43, 0
  s_cbranch_scc1 L_t_yw
  s_mov_b32 s59, 2
  s_add_u32 s59, s59, 1
  s_add_u32 s59, s59, 1
  s_barrier
L_t_yl0:
  s_lshr_b32 s52, s59, 1
  s_lshl_b32 s52, s52, 2
  s_lshr_b32 s52, 0x75364210, s52
  s_lshl_b32 s53, s47, 1
  s_add_u32 s63, s52, s53
  s_and_b32 s63, s63, 7
L_t_c0:
  s_bitcmp1_b32 s62, s63
  s_cbranch_scc1 L_t_c0_ok
  buffer_load_dword v227, v226, s[68:71], 0 offen sc1
  s_waitcnt vmcnt(0)
  v_cmp_eq_u32 vcc, s93, v227
  s_nop 1
    s_or_b32 s62, s62, vcc_lo
  s_bitcmp1_b32 s62, s63
  s_cbranch_scc1 L_t_c0_ok
  s_add_u32 s99, s99, 1
  s_cmp_gt_u32 s99, 0x40000
  s_cbranch_scc1 L_end
  s_sleep 2
  s_branch L_t_c0
L_t_c0_ok:
  s_lshl_b32 s52, s59, 1
  s_add_u32 s52, s52, s88
  s_add_u32 s53, s52, 4
  s_and_b32 s53, s53, 7
  s_mul_i32 s61, s53, 18432
  s_and_b32 s52, s52, 3
  s_lshl_b32 s53, s63, 2
  s_add_u32 s52, s52, s53
  s_lshl_b32 s60, s52, 10
  s_add_u32 m0, s61, 0
  s_add_u32 s52, s60, 0
  buffer_load_dwordx4 v225, s[76:79], s52 offen sc1 lds
  s_add_u32 m0, s61, 1024
  s_add_u32 s52, s60, 131072
  buffer_load_dwordx4 v225, s[76:79], s52 offen sc1 lds
  s_add_u32 m0, s61, 2048
  s_add_u32 s52, s60, 262144
  buffer_load_dwordx4 v225, s[76:79], s52 offen sc1 lds
  s_add_u32 m0, s61, 3072
  s_add_u32 s52, s60, 393216
  buffer_load_dwordx4 v225, s[76:79], s52 offen sc1 lds
  s_add_u32 m0, s61, 4096
  s_add_u32 s52, s60, 524288
  buffer_load_dwordx4 v225, s[76:79], s52 offen sc1 lds
  s_add_u32 m0, s61, 5120
  s_add_u32 s52, s60, 655360
  buffer_load_dwordx4 v225, s[76:79], s52 offen sc1 lds
  s_add_u32 m0, s61, 6144
  s_add_u32 s52, s60, 786432
  buffer_load_dwordx4 v225, s[76:79], s52 offen sc1 lds
  s_add_u32 m0, s61, 7168
  s_add_u32 s52, s60, 917504
  buffer_load_dwordx4 v225, s[76:79], s52 offen sc1 lds
  s_add_u32 m0, s61, 8192
  s_add_u32 s52, s60, 1048576
  buffer_load_dwordx4 v225, s[76:79], s52 offen sc1 lds
  buffer_load_dword v227, v226, s[68:71], 0 offen sc1
  s_add_u32 s59, s59, 1
  s_waitcnt vmcnt(20)
  s_barrier
  v_cmp_eq_u32 vcc, s93, v227
  s_nop 1
    s_or_b32 s62, s62, vcc_lo
  s_cmp_lt_u32 s59, 16
  s_cbranch_scc1 L_t_yl0
  s_waitcnt vmcnt(10)
  s_barrier
  s_waitcnt vmcnt(0)
  s_barrier
  s_branch L_t_ex
L_t_yw:
  s_mov_b32 s59, 2
  s_lshr_b32 s52, s59, 1
  s_lshl_b32 s52, s52, 2
  s_lshr_b32 s52, 0x75364210, s52
  s_lshl_b32 s53, s47, 1
  s_add_u32 s63, s52, s53
  s_and_b32 s63, s63, 7
  s_lshl_b32 s52, s59, 1
  s_add_u32 s52, s52, s88
  s_add_u32 s53, s52, 4
  s_and_b32 s53, s53, 7
  s_mul_i32 s61, s53, 18432
  s_and_b32 s52, s52, 3
  s_lshl_b32 s53, s63, 2
  s_add_u32 s52, s52, s53
  s_mul_i32 s60, s52, 36864
  s_add_u32 m0, s61, 9216
  s_nop 0
  buffer_load_dwordx4 v216, s[80:83], s60 offen lds
  s_add_u32 m0, s61, 10240
  s_nop 0
  buffer_load_dwordx4 v217, s[80:83], s60 offen lds
  s_add_u32 m0, s61, 11264
  s_nop 0
  buffer_load_dwordx4 v218, s[80:83], s60 offen lds
  s_add_u32 m0, s61, 12288
  s_nop 0
  buffer_load_dwordx4 v219, s[80:83], s60 offen lds
  s_add_u32 m0, s61, 13312
  s_nop 0
  buffer_load_dwordx4 v220, s[80:83], s60 offen lds
  s_add_u32 m0, s61, 14336
  s_nop 0
  buffer_load_dwordx4 v221, s[80:83], s60 offen lds
  s_add_u32 m0, s61, 15360
  s_nop 0
  buffer_load_dwordx4 v222, s[80:83], s60 offen lds
  s_add_u32 m0, s61, 16384
  s_nop 0
  buffer_load_dwordx4 v223, s[80:83], s60 offen lds
  s_add_u32 m0, s61, 17408
  s_nop 0
  buffer_load_dwordx4 v224, s[80:83], s60 offen lds
  s_add_u32 s59, s59, 1
  s_lshr_b32 s52, s59, 1
  s_lshl_b32 s52, s52, 2
  s_lshr_b32 s52, 0x75364210, s52
  s_lshl_b32 s53, s47, 1
  s_add_u32 s63, s52, s53
  s_and_b32 s63, s63, 7
  s_lshl_b32 s52, s59, 1
  s_add_u32 s52, s52, s88
  s_add_u32 s53, s52, 4
  s_and_b32 s53, s53, 7
  s_mul_i32 s61, s53, 18432
  s_and_b32 s52, s52, 3
  s_lshl_b32 s53, s63, 2
  s_add_u32 s52, s52, s53
  s_mul_i32 s60, s52, 36864
  s_add_u32 m0, s61, 9216
  s_nop 0
  buffer_load_dwordx4 v216, s[80:83], s60 offen lds
  s_add_u32 m0, s61, 10240
  s_nop 0
  buffer_load_dwordx4 v217, s[80:83], s60 offen lds
  s_add_u32 m0, s61, 11264
  s_nop 0
  buffer_load_dwordx4 v218, s[80:83], s60 offen lds
  s_add_u32 m0, s61, 12288
  s_nop 0
  buffer_load_dwordx4 v219, s[80:83], s60 offen lds
  s_add_u32 m0, s61, 13312
  s_nop 0
  buffer_load_dwordx4 v220, s[80:83], s60 offen lds
  s_add_u32 m0, s61, 14336
  s_nop 0
  buffer_load_dwordx4 v221, s[80:83], s60 offen lds
  s_add_u32 m0, s61, 15360
  s_nop 0
  buffer_load_dwordx4 v222, s[80:83], s60 offen lds
  s_add_u32 m0, s61, 16384
  s_nop 0
  buffer_load_dwordx4 v223, s[80:83], s60 offen lds
  s_add_u32 m0, s61, 17408
  s_nop 0
  buffer_load_dwordx4 v224, s[80:83], s60 offen lds
  s_add_u32 s59, s59, 1
  s_barrier
L_t_yl1:
  s_lshr_b32 s52, s59, 1
  s_lshl_b32 s52, s52, 2
  s_lshr_b32 s52, 0x75364210, s52
  s_lshl_b32 s53, s47, 1
  s_add_u32 s63, s52, s53
  s_and_b32 s63, s63, 7
  s_lshl_b32 s52, s59, 1
  s_add_u32 s52, s52, s88
  s_add_u32 s53, s52, 4
  s_and_b32 s53, s53, 7
  s_mul_i32 s61, s53, 18432
  s_and_b32 s52, s52, 3
  s_lshl_b32 s53, s63, 2
  s_add_u32 s52, s52, s53
  s_mul_i32 s60, s52, 36864
  s_add_u32 m0, s61, 9216
  s_nop 0
  buffer_load_dwordx4 v216, s[80:83], s60 offen lds
  s_add_u32 m0, s61, 10240
  s_nop 0
  buffer_load_dwordx4 v217, s[80:83], s60 offen lds
  s_add_u32 m0, s61, 11264
  s_nop 0
  buffer_load_dwordx4 v218, s[80:83], s60 offen lds
  s_add_u32 m0, s61, 12288
  s_nop 0
  buffer_load_dwordx4 v219, s[80:83], s60 offen lds
  s_add_u32 m0, s61, 13312
  s_nop 0
  buffer_load_dwordx4 v220, s[80:83], s60 offen lds
  s_add_u32 m0, s61, 14336
  s_nop 0
  buffer_load_dwordx4 v221, s[80:83], s60 offen lds
  s_add_u32 m0, s61, 15360
  s_nop 0
  buffer_load_dwordx4 v222, s[80:83], s60 offen lds
  s_add_u32 m0, s61, 16384
  s_nop 0
  buffer_load_dwordx4 v223, s[80:83], s60 offen lds
  s_add_u32 m0, s61, 17408
  s_nop 0
  buffer_load_dwordx4 v224, s[80:83], s60 offen lds
  s_add_u32 s59, s59, 1
  s_waitcnt vmcnt(18)
  s_barrier
  s_cmp_lt_u32 s59, 16
  s_cbranch_scc1 L_t_yl1
  s_waitcnt vmcnt(9)
  s_barrier
  s_waitcnt vmcnt(0)
  s_barrier
  s_branch L_t_ex
L_t_x01:
  v_mov_b64 v[8:9], 0
  v_mov_b64 v[10:11], 0
  v_mov_b64 v[12:13], 0
  v_mov_b64 v[14:15], 0
  v_mov_b64 v[16:17], 0
  v_mov_b64 v[18:19], 0
  v_mov_b64 v[20:21], 0
  v_mov_b64 v[22:23], 0
  v_mov_b64 v[24:25], 0
  v_mov_b64 v[26:27], 0
  v_mov_b64 v[28:29], 0
  v_mov_b64 v[30:31], 0
  v_mov_b64 v[32:33], 0
  v_mov_b64 v[34:35], 0
  v_mov_b64 v[36:37], 0
  v_mov_b64 v[38:39], 0
  v_mov_b64 v[40:41], 0
  v_mov_b64 v[42:43], 0
  v_mov_b64 v[44:45], 0
  v_mov_b64 v[46:47], 0
  v_mov_b64 v[48:49], 0
  v_mov_b64 v[50:51], 0
  v_mov_b64 v[52:53], 0
  v_mov_b64 v[54:55], 0
  v_mov_b64 v[56:57], 0
  v_mov_b64 v[58:59], 0
  v_mov_b64 v[60:61], 0
  v_mov_b64 v[62:63], 0
  v_mov_b64 v[64:65], 0
  v_mov_b64 v[66:67], 0
  v_mov_b64 v[68:69], 0
  v_mov_b64 v[70:71], 0
  v_mov_b64 v[72:73], 0
  v_mov_b64 v[74:75], 0
  v_mov_b64 v[76:77], 0
  v_mov_b64 v[78:79], 0
  v_mov_b64 v[80:81], 0
  v_mov_b64 v[82:83], 0
  v_mov_b64 v[84:85], 0
  v_mov_b64 v[86:87], 0
  v_mov_b64 v[88:89], 0
  v_mov_b64 v[90:91], 0
L_t_x:
  s_setprio 2
  v_mov_b64 v[104:105], 0
  v_mov_b64 v[106:107], 0
  v_mov_b64 v[108:109], 0
  v_mov_b64 v[110:111], 0
  v_mov_b64 v[112:113], 0
  v_mov_b64 v[114:115], 0
  v_mov_b64 v[152:153], 0
  v_mov_b64 v[154:155], 0
  v_mov_b64 v[156:157], 0
  v_mov_b64 v[158:159], 0
  v_mov_b64 v[160:161], 0
  v_mov_b64 v[162:163], 0
  v_mov_b64 v[164:165], 0
  v_mov_b64 v[166:167], 0
  v_mov_b64 v[168:169], 0
  v_mov_b64 v[170:171], 0
  v_mov_b64 v[172:173], 0
  v_mov_b64 v[174:175], 0
  v_mov_b64 v[176:177], 0
  v_mov_b64 v[178:179], 0
  v_mov_b64 v[180:181], 0
  v_mov_b64 v[182:183], 0
  v_mov_b64 v[184:185], 0
  v_mov_b64 v[186:187], 0
  v_lshlrev_b32 v225, 4, v0
  s_mov_b32 s59, 0
  v_mov_b32 v233, 163680
L_t_tagy:
  ds_read_b32 v232, v233 offset:0
  s_waitcnt lgkmcnt(0)
  v_cmp_le_u32 vcc, 1, v232
  s_cbranch_vccnz L_t_tagy_ok
  s_add_u32 s99, s99, 1
  s_cmp_gt_u32 s99, 0x40000
  s_cbranch_scc1 L_end
  s_sleep 2
  s_branch L_t_tagy
L_t_tagy_ok:
  v_readfirstlane_b32 s93, v232
  s_waitcnt vmcnt(0) lgkmcnt(0)
  s_branch L_t_x2
  s_cmp_ge_u32 s42, 2
  s_cbranch_scc1 L_t_x2
  s_mul_i32 s52, s42, 20480
  s_add_u32 s52, s52, 73728
  v_add_u32 v228, s52, v225
  ds_read_b128 v[8:11], v228 offset:0
  ds_read_b128 v[12:15], v228 offset:1024
  ds_read_b128 v[16:19], v228 offset:2048
  ds_read_b128 v[20:23], v228 offset:3072
  ds_read_b128 v[24:27], v228 offset:4096
  ds_read_b128 v[28:31], v228 offset:5120
  ds_read_b128 v[32:35], v228 offset:6144
  ds_read_b128 v[36:39], v228 offset:7168
  ds_read_b128 v[40:43], v228 offset:8192
  ds_read_b128 v[44:47], v228 offset:9216
  ds_read_b128 v[48:51], v228 offset:10240
  ds_read_b128 v[52:55], v228 offset:11264
  ds_read_b128 v[56:59], v228 offset:12288
  ds_read_b128 v[60:63], v228 offset:13312
  ds_read_b128 v[64:67], v228 offset:14336
  ds_read_b128 v[68:71], v228 offset:15360
  ds_read_b128 v[72:75], v228 offset:16384
  ds_read_b128 v[76:79], v228 offset:17408
  ds_read_b128 v[80:83], v228 offset:18432
  ds_read_b128 v[84:87], v228 offset:19456
L_t_x2:
  s_lshl_b32 s52, s55, 2
  s_add_u32 s63, s52, s47
  s_mul_i32 s52, s63, 344064
  s_add_u32 s52, s52, 41943040
  s_add_u32 s76, s18, s52
  s_addc_u32 s77, s19, 0
  s_mov_b32 s78, 344064
  s_mov_b32 s79, 0x20000
  s_lshl_b32 s52, s63, 6
  s_add_u32 s52, s52, 33558528
  s_add_u32 s80, s18, s52
  s_addc_u32 s81, s19, 0
  s_mov_b32 s82, 64
  s_mov_b32 s83, 0x20000
  s_cmp_eq_u32 s42, 1
  s_cbranch_scc1 L_t_v1
  s_cmp_eq_u32 s42, 2
  s_cbranch_scc1 L_t_v2
  s_cmp_eq_u32 s42, 3
  s_cbranch_scc1 L_t_v3
L_t_v0:
  s_mov_b32 s52, 75776
  v_lshl_add_u32 v228, v0, 4, s52
  v_lshrrev_b32 v232, 2, v2
  v_lshl_add_u32 v232, v3, 2, v232
  v_mul_u32_u24 v232, 288, v232
  v_and_b32 v233, 3, v0
  v_lshl_add_u32 v232, v233, 3, v232
  v_add_u32 v229, 82944, v232
  s_waitcnt lgkmcnt(0)
L_t_xl0:
  s_barrier
  s_add_u32 s59, s59, 1
  s_and_b32 s52, s59, 3
  s_cmp_eq_u32 s52, 2
  s_cselect_b32 s52, -3, 1
  s_mul_i32 s52, s52, 36864
  v_mfma_f32_16x16x32_bf16 v[32:35], v[152:155], v[108:111], v[32:35]
  ds_read_b128 v[92:95], v228 offset:0
  v_mfma_f32_16x16x32_bf16 v[68:71], v[152:155], v[112:115], v[68:71]
  ds_read_b128 v[96:99], v228 offset:1024
  v_mfma_f32_16x16x32_bf16 v[36:39], v[156:159], v[108:111], v[36:39]
  ds_read_b128 v[100:103], v228 offset:2048
  v_mfma_f32_16x16x32_bf16 v[72:75], v[156:159], v[112:115], v[72:75]
  ds_read_b64_tr_b16 v[116:117], v229 offset:0
  v_mfma_f32_16x16x32_bf16 v[40:43], v[160:163], v[108:111], v[40:43]
  ds_read_b64_tr_b16 v[118:119], v229 offset:4608
  ds_read_b64_tr_b16 v[120:121], v229 offset:32
  v_mfma_f32_16x16x32_bf16 v[76:79], v[160:163], v[112:115], v[76:79]
  ds_read_b64_tr_b16 v[122:123], v229 offset:4640
  v_mfma_f32_16x16x32_bf16 v[8:11], v[164:167], v[104:107], v[8:11]
  ds_read_b64_tr_b16 v[124:125], v229 offset:64
  v_mfma_f32_16x16x32_bf16 v[44:47], v[164:167], v[108:111], v[44:47]
  ds_read_b64_tr_b16 v[126:127], v229 offset:4672
  v_mfma_f32_16x16x32_bf16 v[80:83], v[164:167], v[112:115], v[80:83]
  ds_read_b64_tr_b16 v[128:129], v229 offset:96
  ds_read_b64_tr_b16 v[130:131], v229 offset:4704
  v_mfma_f32_16x16x32_bf16 v[12:15], v[168:171], v[104:107], v[12:15]
  ds_read_b64_tr_b16 v[132:133], v229 offset:128
  v_mfma_f32_16x16x32_bf16 v[48:51], v[168:171], v[108:111], v[48:51]
  ds_read_b64_tr_b16 v[134:135], v229 offset:4736
  v_mfma_f32_16x16x32_bf16 v[84:87], v[168:171], v[112:115], v[84:87]
  ds_read_b64_tr_b16 v[136:137], v229 offset:160
  v_mfma_f32_16x16x32_bf16 v[16:19], v[172:175], v[104:107], v[16:19]
  ds_read_b64_tr_b16 v[138:139], v229 offset:4768
  ds_read_b64_tr_b16 v[140:141], v229 offset:192
  v_mfma_f32_16x16x32_bf16 v[52:55], v[172:175], v[108:111], v[52:55]
  ds_read_b64_tr_b16 v[142:143], v229 offset:4800
  v_mfma_f32_16x16x32_bf16 v[20:23], v[176:179], v[104:107], v[20:23]
  ds_read_b64_tr_b16 v[144:145], v229 offset:224
  v_mfma_f32_16x16x32_bf16 v[56:59], v[176:179], v[108:111], v[56:59]
  ds_read_b64_tr_b16 v[146:147], v229 offset:4832
  v_mfma_f32_16x16x32_bf16 v[24:27], v[180:183], v[104:107], v[24:27]
  ds_read_b64_tr_b16 v[148:149], v229 offset:256
  ds_read_b64_tr_b16 v[150:151], v229 offset:4864
  v_mfma_f32_16x16x32_bf16 v[60:63], v[180:183], v[108:111], v[60:63]
  v_mfma_f32_16x16x32_bf16 v[28:31], v[184:187], v[104:107], v[28:31]
  v_mfma_f32_16x16x32_bf16 v[64:67], v[184:187], v[108:111], v[64:67]
  s_waitcnt lgkmcnt(5)
  v_mfma_f32_16x16x32_bf16 v[32:35], v[116:119], v[96:99], v[32:35]
  ds_read_b128 v[104:107], v228 offset:18432
  v_mfma_f32_16x16x32_bf16 v[68:71], v[116:119], v[100:103], v[68:71]
  ds_read_b128 v[108:111], v228 offset:19456
  v_mfma_f32_16x16x32_bf16 v[36:39], v[120:123], v[96:99], v[36:39]
  ds_read_b128 v[112:115], v228 offset:20480
  v_mfma_f32_16x16x32_bf16 v[72:75], v[120:123], v[100:103], v[72:75]
  ds_read_b64_tr_b16 v[152:153], v229 offset:18432
  v_mfma_f32_16x16x32_bf16 v[40:43], v[124:127], v[96:99], v[40:43]
  ds_read_b64_tr_b16 v[154:155], v229 offset:23040
  ds_read_b64_tr_b16 v[156:157], v229 offset:18464
  v_mfma_f32_16x16x32_bf16 v[76:79], v[124:127], v[100:103], v[76:79]
  ds_read_b64_tr_b16 v[158:159], v229 offset:23072
  v_mfma_f32_16x16x32_bf16 v[8:11], v[128:131], v[92:95], v[8:11]
  ds_read_b64_tr_b16 v[160:161], v229 offset:18496
  v_mfma_f32_16x16x32_bf16 v[44:47], v[128:131], v[96:99], v[44:47]
  ds_read_b64_tr_b16 v[162:163], v229 offset:23104
  v_mfma_f32_16x16x32_bf16 v[80:83], v[128:131], v[100:103], v[80:83]
  ds_read_b64_tr_b16 v[164:165], v229 offset:18528
  ds_read_b64_tr_b16 v[166:167], v229 offset:23136
  v_mfma_f32_16x16x32_bf16 v[12:15], v[132:135], v[92:95], v[12:15]
  ds_read_b64_tr_b16 v[168:169], v229 offset:18560
  v_mfma_f32_16x16x32_bf16 v[48:51], v[132:135], v[96:99], v[48:51]
  ds_read_b64_tr_b16 v[170:171], v229 offset:23168
  v_mfma_f32_16x16x32_bf16 v[84:87], v[132:135], v[100:103], v[84:87]
  ds_read_b64_tr_b16 v[172:173], v229 offset:18592
  v_mfma_f32_16x16x32_bf16 v[16:19], v[136:139], v[92:95], v[16:19]
  ds_read_b64_tr_b16 v[174:175], v229 offset:23200
  ds_read_b64_tr_b16 v[176:177], v229 offset:18624
  v_mfma_f32_16x16x32_bf16 v[52:55], v[136:139], v[96:99], v[52:55]
  ds_read_b64_tr_b16 v[178:179], v229 offset:23232
  s_waitcnt lgkmcnt(7)
  v_mfma_f32_16x16x32_bf16 v[20:23], v[140:143], v[92:95], v[20:23]
  ds_read_b64_tr_b16 v[180:181], v229 offset:18656
  v_mfma_f32_16x16x32_bf16 v[56:59], v[140:143], v[96:99], v[56:59]
  ds_read_b64_tr_b16 v[182:183], v229 offset:23264
  v_mfma_f32_16x16x32_bf16 v[24:27], v[144:147], v[92:95], v[24:27]
  ds_read_b64_tr_b16 v[184:185], v229 offset:18688
  ds_read_b64_tr_b16 v[186:187], v229 offset:23296
  v_add_u32 v228, s52, v228
  v_add_u32 v229, s52, v229
  v_mfma_f32_16x16x32_bf16 v[60:63], v[144:147], v[96:99], v[60:63]
  v_mfma_f32_16x16x32_bf16 v[28:31], v[148:151], v[92:95], v[28:31]
  v_mfma_f32_16x16x32_bf16 v[64:67], v[148:151], v[96:99], v[64:67]
  s_cmp_lt_u32 s59, 16
  s_waitcnt lgkmcnt(0)
  s_cbranch_scc1 L_t_xl0
  v_mfma_f32_16x16x32_bf16 v[32:35], v[152:155], v[108:111], v[32:35]
  v_mfma_f32_16x16x32_bf16 v[68:71], v[152:155], v[112:115], v[68:71]
  v_mfma_f32_16x16x32_bf16 v[36:39], v[156:159], v[108:111], v[36:39]
  v_mfma_f32_16x16x32_bf16 v[72:75], v[156:159], v[112:115], v[72:75]
  v_mfma_f32_16x16x32_bf16 v[40:43], v[160:163], v[108:111], v[40:43]
  v_mfma_f32_16x16x32_bf16 v[76:79], v[160:163], v[112:115], v[76:79]
  v_mfma_f32_16x16x32_bf16 v[8:11], v[164:167], v[104:107], v[8:11]
  v_mfma_f32_16x16x32_bf16 v[44:47], v[164:167], v[108:111], v[44:47]
  v_mfma_f32_16x16x32_bf16 v[80:83], v[164:167], v[112:115], v[80:83]
  v_mfma_f32_16x16x32_bf16 v[12:15], v[168:171], v[104:107], v[12:15]
  v_mfma_f32_16x16x32_bf16 v[48:51], v[168:171], v[108:111], v[48:51]
  v_mfma_f32_16x16x32_bf16 v[84:87], v[168:171], v[112:115], v[84:87]
  v_mfma_f32_16x16x32_bf16 v[16:19], v[172:175], v[104:107], v[16:19]
  v_mfma_f32_16x16x32_bf16 v[52:55], v[172:175], v[108:111], v[52:55]
  v_mfma_f32_16x16x32_bf16 v[20:23], v[176:179], v[104:107], v[20:23]
  v_mfma_f32_16x16x32_bf16 v[56:59], v[176:179], v[108:111], v[56:59]
  v_mfma_f32_16x16x32_bf16 v[24:27], v[180:183], v[104:107], v[24:27]
  v_mfma_f32_16x16x32_bf16 v[60:63], v[180:183], v[108:111], v[60:63]
  v_mfma_f32_16x16x32_bf16 v[28:31], v[184:187], v[104:107], v[28:31]
  v_mfma_f32_16x16x32_bf16 v[64:67], v[184:187], v[108:111], v[64:67]
  s_mov_b32 s61, 1
  s_cmp_eq_u32 s3, 1
  s_cbranch_scc1 L_t_own
  s_branch L_t_send
L_t_v1:
  s_mov_b32 s52, 79872
  v_lshl_add_u32 v228, v0, 4, s52
  v_lshrrev_b32 v232, 2, v2
  v_lshl_add_u32 v232, v3, 2, v232
  v_mul_u32_u24 v232, 288, v232
  v_and_b32 v233, 3, v0
  v_lshl_add_u32 v232, v233, 3, v232
  v_add_u32 v229, 82944, v232
  s_waitcnt lgkmcnt(0)
L_t_xl1:
  s_barrier
  s_add_u32 s59, s59, 1
  s_and_b32 s52, s59, 3
  s_cmp_eq_u32 s52, 2
  s_cselect_b32 s52, -3, 1
  s_mul_i32 s52, s52, 36864
  v_mfma_f32_16x16x32_bf16 v[16:19], v[152:155], v[108:111], v[16:19]
  ds_read_b128 v[92:95], v228 offset:0
  v_mfma_f32_16x16x32_bf16 v[52:55], v[152:155], v[112:115], v[52:55]
  ds_read_b128 v[96:99], v228 offset:1024
  v_mfma_f32_16x16x32_bf16 v[20:23], v[156:159], v[108:111], v[20:23]
  ds_read_b128 v[100:103], v228 offset:2048
  v_mfma_f32_16x16x32_bf16 v[56:59], v[156:159], v[112:115], v[56:59]
  ds_read_b64_tr_b16 v[116:117], v229 offset:0
  v_mfma_f32_16x16x32_bf16 v[24:27], v[160:163], v[108:111], v[24:27]
  ds_read_b64_tr_b16 v[118:119], v229 offset:4608
  ds_read_b64_tr_b16 v[120:121], v229 offset:32
  v_mfma_f32_16x16x32_bf16 v[60:63], v[160:163], v[112:115], v[60:63]
  ds_read_b64_tr_b16 v[122:123], v229 offset:4640
  v_mfma_f32_16x16x32_bf16 v[28:31], v[164:167], v[108:111], v[28:31]
  ds_read_b64_tr_b16 v[124:125], v229 offset:64
  v_mfma_f32_16x16x32_bf16 v[64:67], v[164:167], v[112:115], v[64:67]
  ds_read_b64_tr_b16 v[126:127], v229 offset:4672
  v_mfma_f32_16x16x32_bf16 v[32:35], v[168:171], v[108:111], v[32:35]
  ds_read_b64_tr_b16 v[128:129], v229 offset:96
  ds_read_b64_tr_b16 v[130:131], v229 offset:4704
  v_mfma_f32_16x16x32_bf16 v[68:71], v[168:171], v[112:115], v[68:71]
  ds_read_b64_tr_b16 v[132:133], v229 offset:128
  v_mfma_f32_16x16x32_bf16 v[36:39], v[172:175], v[108:111], v[36:39]
  ds_read_b64_tr_b16 v[134:135], v229 offset:4736
  v_mfma_f32_16x16x32_bf16 v[72:75], v[172:175], v[112:115], v[72:75]
  ds_read_b64_tr_b16 v[136:137], v229 offset:160
  v_mfma_f32_16x16x32_bf16 v[40:43], v[176:179], v[108:111], v[40:43]
  ds_read_b64_tr_b16 v[138:139], v229 offset:4768
  ds_read_b64_tr_b16 v[140:141], v229 offset:192
  v_mfma_f32_16x16x32_bf16 v[76:79], v[176:179], v[112:115], v[76:79]
  ds_read_b64_tr_b16 v[142:143], v229 offset:4800
  v_mfma_f32_16x16x32_bf16 v[8:11], v[180:183], v[104:107], v[8:11]
  ds_read_b64_tr_b16 v[144:145], v229 offset:224
  v_mfma_f32_16x16x32_bf16 v[44:47], v[180:183], v[108:111], v[44:47]
  ds_read_b64_tr_b16 v[146:147], v229 offset:4832
  v_mfma_f32_16x16x32_bf16 v[80:83], v[180:183], v[112:115], v[80:83]
  ds_read_b64_tr_b16 v[148:149], v229 offset:256
  ds_read_b64_tr_b16 v[150:151], v229 offset:4864
  v_mfma_f32_16x16x32_bf16 v[12:15], v[184:187], v[104:107], v[12:15]
  v_mfma_f32_16x16x32_bf16 v[48:51], v[184:187], v[108:111], v[48:51]
  v_mfma_f32_16x16x32_bf16 v[84:87], v[184:187], v[112:115], v[84:87]
  s_waitcnt lgkmcnt(5)
  v_mfma_f32_16x16x32_bf16 v[16:19], v[116:119], v[96:99], v[16:19]
  ds_read_b128 v[104:107], v228 offset:18432
  v_mfma_f32_16x16x32_bf16 v[52:55], v[116:119], v[100:103], v[52:55]
  ds_read_b128 v[108:111], v228 offset:19456
  v_mfma_f32_16x16x32_bf16 v[20:23], v[120:123], v[96:99], v[20:23]
  ds_read_b128 v[112:115], v228 offset:20480
  v_mfma_f32_16x16x32_bf16 v[56:59], v[120:123], v[100:103], v[56:59]
  ds_read_b64_tr_b16 v[152:153], v229 offset:18432
  v_mfma_f32_16x16x32_bf16 v[24:27], v[124:127], v[96:99], v[24:27]
  ds_read_b64_tr_b16 v[154:155], v229 offset:23040
  ds_read_b64_tr_b16 v[156:157], v229 offset:18464
  v_mfma_f32_16x16x32_bf16 v[60:63], v[124:127], v[100:103], v[60:63]
  ds_read_b64_tr_b16 v[158:159], v229 offset:23072
  v_mfma_f32_16x16x32_bf16 v[28:31], v[128:131], v[96:99], v[28:31]
  ds_read_b64_tr_b16 v[160:161], v229 offset:18496
  v_mfma_f32_16x16x32_bf16 v[64:67], v[128:131], v[100:103], v[64:67]
  ds_read_b64_tr_b16 v[162:163], v229 offset:23104
  v_mfma_f32_16x16x32_bf16 v[32:35], v[132:135], v[96:99], v[32:35]
  ds_read_b64_tr_b16 v[164:165], v229 offset:18528
  ds_read_b64_tr_b16 v[166:167], v229 offset:23136
  v_mfma_f32_16x16x32_bf16 v[68:71], v[132:135], v[100:103], v[68:71]
  ds_read_b64_tr_b16 v[168:169], v229 offset:18560
  v_mfma_f32_16x16x32_bf16 v[36:39], v[136:139], v[96:99], v[36:39]
  ds_read_b64_tr_b16 v[170:171], v229 offset:23168
  v_mfma_f32_16x16x32_bf16 v[72:75], v[136:139], v[100:103], v[72:75]
  ds_read_b64_tr_b16 v[172:173], v229 offset:18592
  s_waitcnt lgkmcnt(7)
  v_mfma_f32_16x16x32_bf16 v[40:43], v[140:143], v[96:99], v[40:43]
  ds_read_b64_tr_b16 v[174:175], v229 offset:23200
  ds_read_b64_tr_b16 v[176:177], v229 offset:18624
  v_mfma_f32_16x16x32_bf16 v[76:79], v[140:143], v[100:103], v[76:79]
  ds_read_b64_tr_b16 v[178:179], v229 offset:23232
  v_mfma_f32_16x16x32_bf16 v[8:11], v[144:147], v[92:95], v[8:11]
  ds_read_b64_tr_b16 v[180:181], v229 offset:18656
  v_mfma_f32_16x16x32_bf16 v[44:47], v[144:147], v[96:99], v[44:47]
  ds_read_b64_tr_b16 v[182:183], v229 offset:23264
  v_mfma_f32_16x16x32_bf16 v[80:83], v[144:147], v[100:103], v[80:83]
  ds_read_b64_tr_b16 v[184:185], v229 offset:18688
  ds_read_b64_tr_b16 v[186:187], v229 offset:23296
  v_add_u32 v228, s52, v228
  v_add_u32 v229, s52, v229
  v_mfma_f32_16x16x32_bf16 v[12:15], v[148:151], v[92:95], v[12:15]
  v_mfma_f32_16x16x32_bf16 v[48:51], v[148:151], v[96:99], v[48:51]
  v_mfma_f32_16x16x32_bf16 v[84:87], v[148:151], v[100:103], v[84:87]
  s_cmp_lt_u32 s59, 16
  s_waitcnt lgkmcnt(0)
  s_cbranch_scc1 L_t_xl1
  v_mfma_f32_16x16x32_bf16 v[16:19], v[152:155], v[108:111], v[16:19]
  v_mfma_f32_16x16x32_bf16 v[52:55], v[152:155], v[112:115], v[52:55]
  v_mfma_f32_16x16x32_bf16 v[20:23], v[156:159], v[108:111], v[20:23]
  v_mfma_f32_16x16x32_bf16 v[56:59], v[156:159], v[112:115], v[56:59]
  v_mfma_f32_16x16x32_bf16 v[24:27], v[160:163], v[108:111], v[24:27]
  v_mfma_f32_16x16x32_bf16 v[60:63], v[160:163], v[112:115], v[60:63]
  v_mfma_f32_16x16x32_bf16 v[28:31], v[164:167], v[108:111], v[28:31]
  v_mfma_f32_16x16x32_bf16 v[64:67], v[164:167], v[112:115], v[64:67]
  v_mfma_f32_16x16x32_bf16 v[32:35], v[168:171], v[108:111], v[32:35]
  v_mfma_f32_16x16x32_bf16 v[68:71], v[168:171], v[112:115], v[68:71]
  v_mfma_f32_16x16x32_bf16 v[36:39], v[172:175], v[108:111], v[36:39]
  v_mfma_f32_16x16x32_bf16 v[72:75], v[172:175], v[112:115], v[72:75]
  v_mfma_f32_16x16x32_bf16 v[40:43], v[176:179], v[108:111], v[40:43]
  v_mfma_f32_16x16x32_bf16 v[76:79], v[176:179], v[112:115], v[76:79]
  v_mfma_f32_16x16x32_bf16 v[8:11], v[180:183], v[104:107], v[8:11]
  v_mfma_f32_16x16x32_bf16 v[44:47], v[180:183], v[108:111], v[44:47]
  v_mfma_f32_16x16x32_bf16 v[80:83], v[180:183], v[112:115], v[80:83]
  v_mfma_f32_16x16x32_bf16 v[12:15], v[184:187], v[104:107], v[12:15]
  v_mfma_f32_16x16x32_bf16 v[48:51], v[184:187], v[108:111], v[48:51]
  v_mfma_f32_16x16x32_bf16 v[84:87], v[184:187], v[112:115], v[84:87]
  s_mov_b32 s61, 3
  s_cmp_eq_u32 s3, 3
  s_cbranch_scc1 L_t_own
  s_branch L_t_send
L_t_v2:
  s_mov_b32 s52, 73728
  v_lshl_add_u32 v228, v0, 4, s52
  v_lshrrev_b32 v232, 2, v2
  v_lshl_add_u32 v232, v3, 2, v232
  v_mul_u32_u24 v232, 288, v232
  v_and_b32 v233, 3, v0
  v_lshl_add_u32 v232, v233, 3, v232
  v_add_u32 v229, 82944, v232
  s_waitcnt lgkmcnt(0)
L_t_xl2:
  s_barrier
  s_add_u32 s59, s59, 1
  s_and_b32 s52, s59, 3
  s_cmp_eq_u32 s52, 2
  s_cselect_b32 s52, -3, 1
  s_mul_i32 s52, s52, 36864
  v_mfma_f32_16x16x32_bf16 v[8:11], v[152:155], v[104:107], v[8:11]
  ds_read_b128 v[92:95], v228 offset:0
  v_mfma_f32_16x16x32_bf16 v[44:47], v[152:155], v[108:111], v[44:47]
  ds_read_b128 v[96:99], v228 offset:1024
  v_mfma_f32_16x16x32_bf16 v[80:83], v[152:155], v[112:115], v[80:83]
  ds_read_b128 v[100:103], v228 offset:2048
  v_mfma_f32_16x16x32_bf16 v[12:15], v[156:159], v[104:107], v[12:15]
  ds_read_b64_tr_b16 v[116:117], v229 offset:0
  v_mfma_f32_16x16x32_bf16 v[48:51], v[156:159], v[108:111], v[48:51]
  ds_read_b64_tr_b16 v[118:119], v229 offset:4608
  ds_read_b64_tr_b16 v[120:121], v229 offset:32
  v_mfma_f32_16x16x32_bf16 v[84:87], v[156:159], v[112:115], v[84:87]
  ds_read_b64_tr_b16 v[122:123], v229 offset:4640
  v_mfma_f32_16x16x32_bf16 v[16:19], v[160:163], v[104:107], v[16:19]
  ds_read_b64_tr_b16 v[124:125], v229 offset:64
  v_mfma_f32_16x16x32_bf16 v[52:55], v[160:163], v[108:111], v[52:55]
  ds_read_b64_tr_b16 v[126:127], v229 offset:4672
  v_mfma_f32_16x16x32_bf16 v[88:91], v[160:163], v[112:115], v[88:91]
  ds_read_b64_tr_b16 v[128:129], v229 offset:96
  ds_read_b64_tr_b16 v[130:131], v229 offset:4704
  v_mfma_f32_16x16x32_bf16 v[20:23], v[164:167], v[104:107], v[20:23]
  ds_read_b64_tr_b16 v[132:133], v229 offset:128
  v_mfma_f32_16x16x32_bf16 v[56:59], v[164:167], v[108:111], v[56:59]
  ds_read_b64_tr_b16 v[134:135], v229 offset:4736
  v_mfma_f32_16x16x32_bf16 v[24:27], v[168:171], v[104:107], v[24:27]
  ds_read_b64_tr_b16 v[136:137], v229 offset:160
  v_mfma_f32_16x16x32_bf16 v[60:63], v[168:171], v[108:111], v[60:63]
  ds_read_b64_tr_b16 v[138:139], v229 offset:4768
  ds_read_b64_tr_b16 v[140:141], v229 offset:192
  v_mfma_f32_16x16x32_bf16 v[28:31], v[172:175], v[104:107], v[28:31]
  ds_read_b64_tr_b16 v[142:143], v229 offset:4800
  v_mfma_f32_16x16x32_bf16 v[64:67], v[172:175], v[108:111], v[64:67]
  ds_read_b64_tr_b16 v[144:145], v229 offset:224
  v_mfma_f32_16x16x32_bf16 v[32:35], v[176:179], v[104:107], v[32:35]
  ds_read_b64_tr_b16 v[146:147], v229 offset:4832
  v_mfma_f32_16x16x32_bf16 v[68:71], v[176:179], v[108:111], v[68:71]
  ds_read_b64_tr_b16 v[148:149], v229 offset:256
  ds_read_b64_tr_b16 v[150:151], v229 offset:4864
  v_mfma_f32_16x16x32_bf16 v[36:39], v[180:183], v[104:107], v[36:39]
  v_mfma_f32_16x16x32_bf16 v[72:75], v[180:183], v[108:111], v[72:75]
  v_mfma_f32_16x16x32_bf16 v[40:43], v[184:187], v[104:107], v[40:43]
  v_mfma_f32_16x16x32_bf16 v[76:79], v[184:187], v[108:111], v[76:79]
  s_waitcnt lgkmcnt(5)
  v_mfma_f32_16x16x32_bf16 v[8:11], v[116:119], v[92:95], v[8:11]
  ds_read_b128 v[104:107], v228 offset:18432
  v_mfma_f32_16x16x32_bf16 v[44:47], v[116:119], v[96:99], v[44:47]
  ds_read_b128 v[108:111], v228 offset:19456
  v_mfma_f32_16x16x32_bf16 v[80:83], v[116:119], v[100:103], v[80:83]
  ds_read_b128 v[112:115], v228 offset:20480
  v_mfma_f32_16x16x32_bf16 v[12:15], v[120:123], v[92:95], v[12:15]
  ds_read_b64_tr_b16 v[152:153], v229 offset:18432
  v_mfma_f32_16x16x32_bf16 v[48:51], v[120:123], v[96:99], v[48:51]
  ds_read_b64_tr_b16 v[154:155], v229 offset:23040
  ds_read_b64_tr_b16 v[156:157], v229 offset:18464
  v_mfma_f32_16x16x32_bf16 v[84:87], v[120:123], v[100:103], v[84:87]
  ds_read_b64_tr_b16 v[158:159], v229 offset:23072
  v_mfma_f32_16x16x32_bf16 v[16:19], v[124:127], v[92:95], v[16:19]
  ds_read_b64_tr_b16 v[160:161], v229 offset:18496
  v_mfma_f32_16x16x32_bf16 v[52:55], v[124:127], v[96:99], v[52:55]
  ds_read_b64_tr_b16 v[162:163], v229 offset:23104
  v_mfma_f32_16x16x32_bf16 v[88:91], v[124:127], v[100:103], v[88:91]
  ds_read_b64_tr_b16 v[164:165], v229 offset:18528
  ds_read_b64_tr_b16 v[166:167], v229 offset:23136
  v_mfma_f32_16x16x32_bf16 v[20:23], v[128:131], v[92:95], v[20:23]
  ds_read_b64_tr_b16 v[168:169], v229 offset:18560
  v_mfma_f32_16x16x32_bf16 v[56:59], v[128:131], v[96:99], v[56:59]
  ds_read_b64_tr_b16 v[170:171], v229 offset:23168
  v_mfma_f32_16x16x32_bf16 v[24:27], v[132:135], v[92:95], v[24:27]
  ds_read_b64_tr_b16 v[172:173], v229 offset:18592
  v_mfma_f32_16x16x32_bf16 v[60:63], v[132:135], v[96:99], v[60:63]
  ds_read_b64_tr_b16 v[174:175], v229 offset:23200
  ds_read_b64_tr_b16 v[176:177], v229 offset:18624
  v_mfma_f32_16x16x32_bf16 v[28:31], v[136:139], v[92:95], v[28:31]
  ds_read_b64_tr_b16 v[178:179], v229 offset:23232
  v_mfma_f32_16x16x32_bf16 v[64:67], v[136:139], v[96:99], v[64:67]
  ds_read_b64_tr_b16 v[180:181], v229 offset:18656
  s_waitcnt lgkmcnt(7)
  v_mfma_f32_16x16x32_bf16 v[32:35], v[140:143], v[92:95], v[32:35]
  ds_read_b64_tr_b16 v[182:183], v229 offset:23264
  v_mfma_f32_16x16x32_bf16 v[68:71], v[140:143], v[96:99], v[68:71]
  ds_read_b64_tr_b16 v[184:185], v229 offset:18688
  ds_read_b64_tr_b16 v[186:187], v229 offset:23296
  v_add_u32 v228, s52, v228
  v_add_u32 v229, s52, v229
  v_mfma_f32_16x16x32_bf16 v[36:39], v[144:147], v[92:95], v[36:39]
  v_mfma_f32_16x16x32_bf16 v[72:75], v[144:147], v[96:99], v[72:75]
  v_mfma_f32_16x16x32_bf16 v[40:43], v[148:151], v[92:95], v[40:43]
  v_mfma_f32_16x16x32_bf16 v[76:79], v[148:151], v[96:99], v[76:79]
  s_cmp_lt_u32 s59, 16
  s_waitcnt lgkmcnt(0)
  s_cbranch_scc1 L_t_xl2
  v_mfma_f32_16x16x32_bf16 v[8:11], v[152:155], v[104:107], v[8:11]
  v_mfma_f32_16x16x32_bf16 v[44:47], v[152:155], v[108:111], v[44:47]
  v_mfma_f32_16x16x32_bf16 v[80:83], v[152:155], v[112:115], v[80:83]
  v_mfma_f32_16x16x32_bf16 v[12:15], v[156:159], v[104:107], v[12:15]
  v_mfma_f32_16x16x32_bf16 v[48:51], v[156:159], v[108:111], v[48:51]
  v_mfma_f32_16x16x32_bf16 v[84:87], v[156:159], v[112:115], v[84:87]
  v_mfma_f32_16x16x32_bf16 v[16:19], v[160:163], v[104:107], v[16:19]
  v_mfma_f32_16x16x32_bf16 v[52:55], v[160:163], v[108:111], v[52:55]
  v_mfma_f32_16x16x32_bf16 v[88:91], v[160:163], v[112:115], v[88:91]
  v_mfma_f32_16x16x32_bf16 v[20:23], v[164:167], v[104:107], v[20:23]
  v_mfma_f32_16x16x32_bf16 v[56:59], v[164:167], v[108:111], v[56:59]
  v_mfma_f32_16x16x32_bf16 v[24:27], v[168:171], v[104:107], v[24:27]
  v_mfma_f32_16x16x32_bf16 v[60:63], v[168:171], v[108:111], v[60:63]
  v_mfma_f32_16x16x32_bf16 v[28:31], v[172:175], v[104:107], v[28:31]
  v_mfma_f32_16x16x32_bf16 v[64:67], v[172:175], v[108:111], v[64:67]
  v_mfma_f32_16x16x32_bf16 v[32:35], v[176:179], v[104:107], v[32:35]
  v_mfma_f32_16x16x32_bf16 v[68:71], v[176:179], v[108:111], v[68:71]
  v_mfma_f32_16x16x32_bf16 v[36:39], v[180:183], v[104:107], v[36:39]
  v_mfma_f32_16x16x32_bf16 v[72:75], v[180:183], v[108:111], v[72:75]
  v_mfma_f32_16x16x32_bf16 v[40:43], v[184:187], v[104:107], v[40:43]
  v_mfma_f32_16x16x32_bf16 v[76:79], v[184:187], v[108:111], v[76:79]
  s_mov_b32 s61, 0
  s_cmp_eq_u32 s3, 0
  s_cbranch_scc1 L_t_own
  s_mul_i32 s60, s3, 21504
  s_add_u32 s52, s60, 20480
  s_nop 4
  buffer_store_dwordx4 v[88:91], v225, s[76:79], s52 offen sc1
  s_branch L_t_send
L_t_v3:
  s_mov_b32 s52, 77824
  v_lshl_add_u32 v228, v0, 4, s52
  v_lshrrev_b32 v232, 2, v2
  v_lshl_add_u32 v232, v3, 2, v232
  v_mul_u32_u24 v232, 288, v232
  v_and_b32 v233, 3, v0
  v_lshl_add_u32 v232, v233, 3, v232
  v_add_u32 v229, 82944, v232
  s_waitcnt lgkmcnt(0)
L_t_xl3:
  s_barrier
  s_add_u32 s59, s59, 1
  s_and_b32 s52, s59, 3
  s_cmp_eq_u32 s52, 2
  s_cselect_b32 s52, -3, 1
  s_mul_i32 s52, s52, 36864
  v_mfma_f32_16x16x32_bf16 v[24:27], v[152:155], v[108:111], v[24:27]
  ds_read_b128 v[92:95], v228 offset:0
  v_mfma_f32_16x16x32_bf16 v[60:63], v[152:155], v[112:115], v[60:63]
  ds_read_b128 v[96:99], v228 offset:1024
  v_mfma_f32_16x16x32_bf16 v[28:31], v[156:159], v[108:111], v[28:31]
  ds_read_b128 v[100:103], v228 offset:2048
  v_mfma_f32_16x16x32_bf16 v[64:67], v[156:159], v[112:115], v[64:67]
  ds_read_b64_tr_b16 v[116:117], v229 offset:0
  v_mfma_f32_16x16x32_bf16 v[32:35], v[160:163], v[108:111], v[32:35]
  ds_read_b64_tr_b16 v[118:119], v229 offset:4608
  ds_read_b64_tr_b16 v[120:121], v229 offset:32
  v_mfma_f32_16x16x32_bf16 v[68:71], v[160:163], v[112:115], v[68:71]
  ds_read_b64_tr_b16 v[122:123], v229 offset:4640
  v_mfma_f32_16x16x32_bf16 v[36:39], v[164:167], v[108:111], v[36:39]
  ds_read_b64_tr_b16 v[124:125], v229 offset:64
  v_mfma_f32_16x16x32_bf16 v[72:75], v[164:167], v[112:115], v[72:75]
  ds_read_b64_tr_b16 v[126:127], v229 offset:4672
  v_mfma_f32_16x16x32_bf16 v[40:43], v[168:171], v[108:111], v[40:43]
  ds_read_b64_tr_b16 v[128:129], v229 offset:96
  ds_read_b64_tr_b16 v[130:131], v229 offset:4704
  v_mfma_f32_16x16x32_bf16 v[76:79], v[168:171], v[112:115], v[76:79]
  ds_read_b64_tr_b16 v[132:133], v229 offset:128
  v_mfma_f32_16x16x32_bf16 v[8:11], v[172:175], v[104:107], v[8:11]
  ds_read_b64_tr_b16 v[134:135], v229 offset:4736
  v_mfma_f32_16x16x32_bf16 v[44:47], v[172:175], v[108:111], v[44:47]
  ds_read_b64_tr_b16 v[136:137], v229 offset:160
  v_mfma_f32_16x16x32_bf16 v[80:83], v[172:175], v[112:115], v[80:83]
  ds_read_b64_tr_b16 v[138:139], v229 offset:4768
  ds_read_b64_tr_b16 v[140:141], v229 offset:192
  v_mfma_f32_16x16x32_bf16 v[12:15], v[176:179], v[104:107], v[12:15]
  ds_read_b64_tr_b16 v[142:143], v229 offset:4800
  v_mfma_f32_16x16x32_bf16 v[48:51], v[176:179], v[108:111], v[48:51]
  ds_read_b64_tr_b16 v[144:145], v229 offset:224
  v_mfma_f32_16x16x32_bf16 v[84:87], v[176:179], v[112:115], v[84:87]
  ds_read_b64_tr_b16 v[146:147], v229 offset:4832
  v_mfma_f32_16x16x32_bf16 v[16:19], v[180:183], v[104:107], v[16:19]
  ds_read_b64_tr_b16 v[148:149], v229 offset:256
  ds_read_b64_tr_b16 v[150:151], v229 offset:4864
  v_mfma_f32_16x16x32_bf16 v[52:55], v[180:183], v[108:111], v[52:55]
  v_mfma_f32_16x16x32_bf16 v[20:23], v[184:187], v[104:107], v[20:23]
  v_mfma_f32_16x16x32_bf16 v[56:59], v[184:187], v[108:111], v[56:59]
  s_waitcnt lgkmcnt(5)
  v_mfma_f32_16x16x32_bf16 v[24:27], v[116:119], v[96:99], v[24:27]
  ds_read_b128 v[104:107], v228 offset:18432
  v_mfma_f32_16x16x32_bf16 v[60:63], v[116:119], v[100:103], v[60:63]
  ds_read_b128 v[108:111], v228 offset:19456
  v_mfma_f32_16x16x32_bf16 v[28:31], v[120:123], v[96:99], v[28:31]
  ds_read_b128 v[112:115], v228 offset:20480
  v_mfma_f32_16x16x32_bf16 v[64:67], v[120:123], v[100:103], v[64:67]
  ds_read_b64_tr_b16 v[152:153], v229 offset:18432
  v_mfma_f32_16x16x32_bf16 v[32:35], v[124:127], v[96:99], v[32:35]
  ds_read_b64_tr_b16 v[154:155], v229 offset:23040
  ds_read_b64_tr_b16 v[156:157], v229 offset:18464
  v_mfma_f32_16x16x32_bf16 v[68:71], v[124:127], v[100:103], v[68:71]
  ds_read_b64_tr_b16 v[158:159], v229 offset:23072
  v_mfma_f32_16x16x32_bf16 v[36:39], v[128:131], v[96:99], v[36:39]
  ds_read_b64_tr_b16 v[160:161], v229 offset:18496
  v_mfma_f32_16x16x32_bf16 v[72:75], v[128:131], v[100:103], v[72:75]
  ds_read_b64_tr_b16 v[162:163], v229 offset:23104
  v_mfma_f32_16x16x32_bf16 v[40:43], v[132:135], v[96:99], v[40:43]
  ds_read_b64_tr_b16 v[164:165], v229 offset:18528
  ds_read_b64_tr_b16 v[166:167], v229 offset:23136
  v_mfma_f32_16x16x32_bf16 v[76:79], v[132:135], v[100:103], v[76:79]
  ds_read_b64_tr_b16 v[168:169], v229 offset:18560
  v_mfma_f32_16x16x32_bf16 v[8:11], v[136:139], v[92:95], v[8:11]
  ds_read_b64_tr_b16 v[170:171], v229 offset:23168
  v_mfma_f32_16x16x32_bf16 v[44:47], v[136:139], v[96:99], v[44:47]
  ds_read_b64_tr_b16 v[172:173], v229 offset:18592
  v_mfma_f32_16x16x32_bf16 v[80:83], v[136:139], v[100:103], v[80:83]
  ds_read_b64_tr_b16 v[174:175], v229 offset:23200
  ds_read_b64_tr_b16 v[176:177], v229 offset:18624
  s_waitcnt lgkmcnt(7)
  v_mfma_f32_16x16x32_bf16 v[12:15], v[140:143], v[92:95], v[12:15]
  ds_read_b64_tr_b16 v[178:179], v229 offset:23232
  v_mfma_f32_16x16x32_bf16 v[48:51], v[140:143], v[96:99], v[48:51]
  ds_read_b64_tr_b16 v[180:181], v229 offset:18656
  v_mfma_f32_16x16x32_bf16 v[84:87], v[140:143], v[100:103], v[84:87]
  ds_read_b64_tr_b16 v[182:183], v229 offset:23264
  v_mfma_f32_16x16x32_bf16 v[16:19], v[144:147], v[92:95], v[16:19]
  ds_read_b64_tr_b16 v[184:185], v229 offset:18688
  ds_read_b64_tr_b16 v[186:187], v229 offset:23296
  v_add_u32 v228, s52, v228
  v_add_u32 v229, s52, v229
  v_mfma_f32_16x16x32_bf16 v[52:55], v[144:147], v[96:99], v[52:55]
  v_mfma_f32_16x16x32_bf16 v[20:23], v[148:151], v[92:95], v[20:23]
  v_mfma_f32_16x16x32_bf16 v[56:59], v[148:151], v[96:99], v[56:59]
  s_cmp_lt_u32 s59, 16
  s_waitcnt lgkmcnt(0)
  s_cbranch_scc1 L_t_xl3
  v_mfma_f32_16x16x32_bf16 v[24:27], v[152:155], v[108:111], v[24:27]
  v_mfma_f32_16x16x32_bf16 v[60:63], v[152:155], v[112:115], v[60:63]
  v_mfma_f32_16x16x32_bf16 v[28:31], v[156:159], v[108:111], v[28:31]
  v_mfma_f32_16x16x32_bf16 v[64:67], v[156:159], v[112:115], v[64:67]
  v_mfma_f32_16x16x32_bf16 v[32:35], v[160:163], v[108:111], v[32:35]
  v_mfma_f32_16x16x32_bf16 v[68:71], v[160:163], v[112:115], v[68:71]
  v_mfma_f32_16x16x32_bf16 v[36:39], v[164:167], v[108:111], v[36:39]
  v_mfma_f32_16x16x32_bf16 v[72:75], v[164:167], v[112:115], v[72:75]
  v_mfma_f32_16x16x32_bf16 v[40:43], v[168:171], v[108:111], v[40:43]
  v_mfma_f32_16x16x32_bf16 v[76:79], v[168:171], v[112:115], v[76:79]
  v_mfma_f32_16x16x32_bf16 v[8:11], v[172:175], v[104:107], v[8:11]
  v_mfma_f32_16x16x32_bf16 v[44:47], v[172:175], v[108:111], v[44:47]
  v_mfma_f32_16x16x32_bf16 v[80:83], v[172:175], v[112:115], v[80:83]
  v_mfma_f32_16x16x32_bf16 v[12:15], v[176:179], v[104:107], v[12:15]
  v_mfma_f32_16x16x32_bf16 v[48:51], v[176:179], v[108:111], v[48:51]
  v_mfma_f32_16x16x32_bf16 v[84:87], v[176:179], v[112:115], v[84:87]
  v_mfma_f32_16x16x32_bf16 v[16:19], v[180:183], v[104:107], v[16:19]
  v_mfma_f32_16x16x32_bf16 v[52:55], v[180:183], v[108:111], v[52:55]
  v_mfma_f32_16x16x32_bf16 v[20:23], v[184:187], v[104:107], v[20:23]
  v_mfma_f32_16x16x32_bf16 v[56:59], v[184:187], v[108:111], v[56:59]
  s_mov_b32 s61, 2
  s_cmp_eq_u32 s3, 2
  s_cbranch_scc1 L_t_own
L_t_send:
  s_lshl_b32 s52, s61, 2
  s_add_u32 s52, s52, s3
  s_mul_i32 s60, s52, 21504
  s_lshl_b32 s61, s52, 2
  s_nop 4
  s_add_u32 s52, s60, 0
  buffer_store_dwordx4 v[8:11], v225, s[76:79], s52 offen offset:0 sc1
  buffer_store_dwordx4 v[12:15], v225, s[76:79], s52 offen offset:1024 sc1
  buffer_store_dwordx4 v[16:19], v225, s[76:79], s52 offen offset:2048 sc1
  buffer_store_dwordx4 v[20:23], v225, s[76:79], s52 offen offset:3072 sc1
  s_add_u32 s52, s60, 4096
  buffer_store_dwordx4 v[24:27], v225, s[76:79], s52 offen offset:0 sc1
  buffer_store_dwordx4 v[28:31], v225, s[76:79], s52 offen offset:1024 sc1
  buffer_store_dwordx4 v[32:35], v225, s[76:79], s52 offen offset:2048 sc1
  buffer_store_dwordx4 v[36:39], v225, s[76:79], s52 offen offset:3072 sc1
  s_add_u32 s52, s60, 8192
  buffer_store_dwordx4 v[40:43], v225, s[76:79], s52 offen offset:0 sc1
  buffer_store_dwordx4 v[44:47], v225, s[76:79], s52 offen offset:1024 sc1
  buffer_store_dwordx4 v[48:51], v225, s[76:79], s52 offen offset:2048 sc1
  buffer_store_dwordx4 v[52:55], v225, s[76:79], s52 offen offset:3072 sc1
  s_add_u32 s52, s60, 12288
  buffer_store_dwordx4 v[56:59], v225, s[76:79], s52 offen offset:0 sc1
  buffer_store_dwordx4 v[60:63], v225, s[76:79], s52 offen offset:1024 sc1
  buffer_store_dwordx4 v[64:67], v225, s[76:79], s52 offen offset:2048 sc1
  buffer_store_dwordx4 v[68:71], v225, s[76:79], s52 offen offset:3072 sc1
  s_add_u32 s52, s60, 16384
  buffer_store_dwordx4 v[72:75], v225, s[76:79], s52 offen offset:0 sc1
  buffer_store_dwordx4 v[76:79], v225, s[76:79], s52 offen offset:1024 sc1
  buffer_store_dwordx4 v[80:83], v225, s[76:79], s52 offen offset:2048 sc1
  buffer_store_dwordx4 v[84:87], v225, s[76:79], s52 offen offset:3072 sc1
  v_mov_b32 v232, s93
  v_mov_b32 v233, 0
  s_barrier
  s_waitcnt vmcnt(0)
  s_mov_b64 exec, 1
  buffer_store_dword v232, v233, s[80:83], s61 offen sc1
  s_mov_b64 exec, -1
  s_branch L_fin
L_t_own:
  s_nop 7
  ds_write_b128 v225, v[8:11] offset:0
  ds_write_b128 v225, v[12:15] offset:1024
  ds_write_b128 v225, v[16:19] offset:2048
  ds_write_b128 v225, v[20:23] offset:3072
  ds_write_b128 v225, v[24:27] offset:4096
  ds_write_b128 v225, v[28:31] offset:5120
  ds_write_b128 v225, v[32:35] offset:6144
  ds_write_b128 v225, v[36:39] offset:7168
  ds_write_b128 v225, v[40:43] offset:8192
  ds_write_b128 v225, v[44:47] offset:9216
  ds_write_b128 v225, v[48:51] offset:10240
  ds_write_b128 v225, v[52:55] offset:11264
  ds_write_b128 v225, v[56:59] offset:12288
  ds_write_b128 v225, v[60:63] offset:13312
  ds_write_b128 v225, v[64:67] offset:14336
  ds_write_b128 v225, v[68:71] offset:15360
  ds_write_b128 v225, v[72:75] offset:16384
  ds_write_b128 v225, v[76:79] offset:17408
  ds_write_b128 v225, v[80:83] offset:18432
  ds_write_b128 v225, v[84:87] offset:19456
  ds_write_b128 v225, v[88:91] offset:20480
  s_waitcnt lgkmcnt(0)
  s_barrier
  s_branch L_fin
L_t_ex:
  s_lshl_b32 s52, s55, 2
  s_add_u32 s63, s52, s47
  s_mul_i32 s52, s63, 344064
  s_add_u32 s52, s52, 41943040
  s_add_u32 s76, s18, s52
  s_addc_u32 s77, s19, 0
  s_mov_b32 s78, 344064
  s_mov_b32 s79, 0x20000
  s_lshl_b32 s52, s63, 6
  s_add_u32 s52, s52, 33558528
  s_add_u32 s80, s18, s52
  s_addc_u32 s81, s19, 0
  s_mov_b32 s82, 64
  s_mov_b32 s83, 0x20000
  v_and_b32 v226, 3, v0
  v_lshlrev_b32 v226, 2, v226
  s_lshl_b32 s52, s3, 4
  v_add_u32 v226, s52, v226
  s_lshl_b32 s62, 1, s3
  s_mul_i32 s52, s55, 165888
  s_mul_i32 s53, s47, 288
  s_add_u32 s52, s52, s53
  s_sub_u32 s54, 2654208, s52
  s_add_u32 s84, s14, s52
  s_addc_u32 s85, s15, 0
  s_mov_b32 s86, s54
  s_mov_b32 s87, 0x20000
  v_mul_u32_u24 v233, 1152, v2
  v_lshl_add_u32 v233, v3, 3, v233
  s_lshl_b32 s52, s43, 10
  v_add_u32 v234, s52, v225
  s_mov_b32 s60, s93
  s_mul_i32 s88, s3, 20
  s_min_u32 s52, s3, 1
  s_add_u32 s88, s88, s52
  s_add_u32 s88, s88, s43
  s_add_u32 s61, s3, s43
  s_add_u32 s52, s88, 0
  s_mul_i32 s53, s52, 57
  s_lshr_b32 s53, s53, 9
  s_mul_i32 s54, s53, 9
  s_sub_u32 s54, s52, s54
  s_mul_i32 s92, s53, 18432
  s_lshl_b32 s52, s54, 5
  s_add_u32 s92, s92, s52
  s_add_u32 s52, s88, 4
  s_mul_i32 s53, s52, 57
  s_lshr_b32 s53, s53, 9
  s_mul_i32 s54, s53, 9
  s_sub_u32 s54, s52, s54
  s_mul_i32 s93, s53, 18432
  s_lshl_b32 s52, s54, 5
  s_add_u32 s93, s93, s52
  s_add_u32 s52, s88, 8
  s_mul_i32 s53, s52, 57
  s_lshr_b32 s53, s53, 9
  s_mul_i32 s54, s53, 9
  s_sub_u32 s54, s52, s54
  s_mul_i32 s94, s53, 18432
  s_lshl_b32 s52, s54, 5
  s_add_u32 s94, s94, s52
  s_add_u32 s52, s88, 12
  s_mul_i32 s53, s52, 57
  s_lshr_b32 s53, s53, 9
  s_mul_i32 s54, s53, 9
  s_sub_u32 s54, s52, s54
  s_mul_i32 s95, s53, 18432
  s_lshl_b32 s52, s54, 5
  s_add_u32 s95, s95, s52
  s_add_u32 s52, s88, 16
  s_mul_i32 s53, s52, 57
  s_lshr_b32 s53, s53, 9
  s_mul_i32 s54, s53, 9
  s_sub_u32 s54, s52, s54
  s_mul_i32 s96, s53, 18432
  s_lshl_b32 s52, s54, 5
  s_add_u32 s96, s96, s52
  s_add_u32 s52, s88, 20
  s_mul_i32 s53, s52, 57
  s_lshr_b32 s53, s53, 9
  s_mul_i32 s54, s53, 9
  s_sub_u32 s54, s52, s54
  s_mul_i32 s97, s53, 18432
  s_lshl_b32 s52, s54, 5
  s_add_u32 s97, s97, s52
  s_cmp_lg_u32 s61, 0
  s_cselect_b32 s97, 0x10000000, s97
  s_barrier
  ds_read_b128 v[8:11], v234 offset:0
  ds_read_b128 v[12:15], v234 offset:4096
  ds_read_b128 v[16:19], v234 offset:8192
  ds_read_b128 v[20:23], v234 offset:12288
  ds_read_b128 v[24:27], v234 offset:16384
  ds_read_b128 v[28:31], v234 offset:20480
  s_add_u32 s63, s3, 1
  s_and_b32 s63, s63, 3
L_t_rp1:
  s_bitcmp1_b32 s62, s63
  s_cbranch_scc1 L_t_rg1
  buffer_load_dword v227, v226, s[80:83], 0 offen sc1
  s_waitcnt vmcnt(0)
  v_cmp_eq_u32 vcc, s60, v227
  s_add_u32 s99, s99, 1
  s_cmp_gt_u32 s99, 0x40000
  s_cbranch_scc1 L_end
    s_or_b32 s62, s62, vcc_lo
  s_branch L_t_rp1
L_t_rg1:
  s_lshl_b32 s53, s3, 2
  s_add_u32 s52, s63, s53
  s_mul_i32 s59, s52, 21504
  s_add_u32 s52, s59, 0
  buffer_load_dwordx4 v[40:43], v234, s[76:79], s52 offen sc1
  s_add_u32 s52, s59, 4096
  buffer_load_dwordx4 v[44:47], v234, s[76:79], s52 offen sc1
  s_add_u32 s52, s59, 8192
  buffer_load_dwordx4 v[48:51], v234, s[76:79], s52 offen sc1
  s_add_u32 s52, s59, 12288
  buffer_load_dwordx4 v[52:55], v234, s[76:79], s52 offen sc1
  s_add_u32 s52, s59, 16384
  buffer_load_dwordx4 v[56:59], v234, s[76:79], s52 offen sc1
  s_add_u32 s52, s59, 20480
  s_and_b32 s53, s97, 0x10000000
  s_or_b32 s52, s52, s53
  buffer_load_dwordx4 v[60:63], v234, s[76:79], s52 offen sc1
  s_add_u32 s63, s3, 2
  s_and_b32 s63, s63, 3
L_t_rp2:
  s_bitcmp1_b32 s62, s63
  s_cbranch_scc1 L_t_rg2
  buffer_load_dword v227, v226, s[80:83], 0 offen sc1
  s_waitcnt vmcnt(0)
  v_cmp_eq_u32 vcc, s60, v227
  s_add_u32 s99, s99, 1
  s_cmp_gt_u32 s99, 0x40000
  s_cbranch_scc1 L_end
    s_or_b32 s62, s62, vcc_lo
  s_branch L_t_rp2
L_t_rg2:
  s_lshl_b32 s53, s3, 2
  s_add_u32 s52, s63, s53
  s_mul_i32 s59, s52, 21504
  s_add_u32 s52, s59, 0
  buffer_load_dwordx4 v[64:67], v234, s[76:79], s52 offen sc1
  s_add_u32 s52, s59, 4096
  buffer_load_dwordx4 v[68:71], v234, s[76:79], s52 offen sc1
  s_add_u32 s52, s59, 8192
  buffer_load_dwordx4 v[72:75], v234, s[76:79], s52 offen sc1
  s_add_u32 s52, s59, 12288
  buffer_load_dwordx4 v[76:79], v234, s[76:79], s52 offen sc1
  s_add_u32 s52, s59, 16384
  buffer_load_dwordx4 v[80:83], v234, s[76:79], s52 offen sc1
  s_add_u32 s52, s59, 20480
  s_and_b32 s53, s97, 0x10000000
  s_or_b32 s52, s52, s53
  buffer_load_dwordx4 v[84:87], v234, s[76:79], s52 offen sc1
  s_add_u32 s63, s3, 3
  s_and_b32 s63, s63, 3
L_t_rp3:
  s_bitcmp1_b32 s62, s63
  s_cbranch_scc1 L_t_rg3
  buffer_load_dword v227, v226, s[80:83], 0 offen sc1
  s_waitcnt vmcnt(0)
  v_cmp_eq_u32 vcc, s60, v227
  s_add_u32 s99, s99, 1
  s_cmp_gt_u32 s99, 0x40000
  s_cbranch_scc1 L_end
    s_or_b32 s62, s62, vcc_lo
  s_branch L_t_rp3
L_t_rg3:
  s_lshl_b32 s53, s3, 2
  s_add_u32 s52, s63, s53
  s_mul_i32 s59, s52, 21504
  s_add_u32 s52, s59, 0
  buffer_load_dwordx4 v[88:91], v234, s[76:79], s52 offen sc1
  s_add_u32 s52, s59, 4096
  buffer_load_dwordx4 v[92:95], v234, s[76:79], s52 offen sc1
  s_add_u32 s52, s59, 8192
  buffer_load_dwordx4 v[96:99], v234, s[76:79], s52 offen sc1
  s_add_u32 s52, s59, 12288
  buffer_load_dwordx4 v[100:103], v234, s[76:79], s52 offen sc1
  s_add_u32 s52, s59, 16384
  buffer_load_dwordx4 v[104:107], v234, s[76:79], s52 offen sc1
  s_add_u32 s52, s59, 20480
  s_and_b32 s53, s97, 0x10000000
  s_or_b32 s52, s52, s53
  buffer_load_dwordx4 v[108:111], v234, s[76:79], s52 offen sc1
  s_waitcnt vmcnt(0) lgkmcnt(0)
  v_pk_add_f32 v[8:9], v[8:9], v[40:41]
  v_pk_add_f32 v[10:11], v[10:11], v[42:43]
  v_pk_add_f32 v[8:9], v[8:9], v[64:65]
  v_pk_add_f32 v[10:11], v[10:11], v[66:67]
  v_pk_add_f32 v[8:9], v[8:9], v[88:89]
  v_pk_add_f32 v[10:11], v[10:11], v[90:91]
  v_cvt_pk_bf16_f32 v130, v8, v9
  v_cvt_pk_bf16_f32 v131, v10, v11
  buffer_store_dwordx2 v[130:131], v233, s[84:87], s92 offen
  v_pk_add_f32 v[12:13], v[12:13], v[44:45]
  v_pk_add_f32 v[14:15], v[14:15], v[46:47]
  v_pk_add_f32 v[12:13], v[12:13], v[68:69]
  v_pk_add_f32 v[14:15], v[14:15], v[70:71]
  v_pk_add_f32 v[12:13], v[12:13], v[92:93]
  v_pk_add_f32 v[14:15], v[14:15], v[94:95]
  v_cvt_pk_bf16_f32 v132, v12, v13
  v_cvt_pk_bf16_f32 v133, v14, v15
  buffer_store_dwordx2 v[132:133], v233, s[84:87], s93 offen
  v_pk_add_f32 v[16:17], v[16:17], v[48:49]
  v_pk_add_f32 v[18:19], v[18:19], v[50:51]
  v_pk_add_f32 v[16:17], v[16:17], v[72:73]
  v_pk_add_f32 v[18:19], v[18:19], v[74:75]
  v_pk_add_f32 v[16:17], v[16:17], v[96:97]
  v_pk_add_f32 v[18:19], v[18:19], v[98:99]
  v_cvt_pk_bf16_f32 v134, v16, v17
  v_cvt_pk_bf16_f32 v135, v18, v19
  buffer_store_dwordx2 v[134:135], v233, s[84:87], s94 offen
  v_pk_add_f32 v[20:21], v[20:21], v[52:53]
  v_pk_add_f32 v[22:23], v[22:23], v[54:55]
  v_pk_add_f32 v[20:21], v[20:21], v[76:77]
  v_pk_add_f32 v[22:23], v[22:23], v[78:79]
  v_pk_add_f32 v[20:21], v[20:21], v[100:101]
  v_pk_add_f32 v[22:23], v[22:23], v[102:103]
  v_cvt_pk_bf16_f32 v136, v20, v21
  v_cvt_pk_bf16_f32 v137, v22, v23
  buffer_store_dwordx2 v[136:137], v233, s[84:87], s95 offen
  v_pk_add_f32 v[24:25], v[24:25], v[56:57]
  v_pk_add_f32 v[26:27], v[26:27], v[58:59]
  v_pk_add_f32 v[24:25], v[24:25], v[80:81]
  v_pk_add_f32 v[26:27], v[26:27], v[82:83]
  v_pk_add_f32 v[24:25], v[24:25], v[104:105]
  v_pk_add_f32 v[26:27], v[26:27], v[106:107]
  v_cvt_pk_bf16_f32 v138, v24, v25
  v_cvt_pk_bf16_f32 v139, v26, v27
  buffer_store_dwordx2 v[138:139], v233, s[84:87], s96 offen
  v_pk_add_f32 v[28:29], v[28:29], v[60:61]
  v_pk_add_f32 v[30:31], v[30:31], v[62:63]
  v_pk_add_f32 v[28:29], v[28:29], v[84:85]
  v_pk_add_f32 v[30:31], v[30:31], v[86:87]
  v_pk_add_f32 v[28:29], v[28:29], v[108:109]
  v_pk_add_f32 v[30:31], v[30:31], v[110:111]
  v_cvt_pk_bf16_f32 v140, v28, v29
  v_cvt_pk_bf16_f32 v141, v30, v31
  buffer_store_dwordx2 v[140:141], v233, s[84:87], s97 offen
L_fin:
L_end:
  s_endpgm
.section .rodata,"a"
.p2align 6
.amdhsa_kernel standalone__mha_block_cached__near_ridge_kernel
  .amdhsa_next_free_vgpr 256
  .amdhsa_next_free_sgpr 102
  .amdhsa_accum_offset 256
  .amdhsa_group_segment_fixed_size 0
  .amdhsa_kernarg_size 64
  .amdhsa_user_sgpr_count 2
  .amdhsa_user_sgpr_kernarg_segment_ptr 1
  .amdhsa_system_sgpr_workgroup_id_x 1
.end_amdhsa_kernel
```
